```python
import torch

def _softmax(x, axis=-1):
    return torch.softmax(x, dim=axis)
def _gelu(x):
    return torch.nn.functional.gelu(x, approximate="tanh")
def _silu(x):
    return torch.nn.functional.silu(x)
def _sigmoid(x):
    return torch.sigmoid(x)
def _layernorm(x, axis=-1, eps=1e-5):
    m = x.mean(dim=axis, keepdim=True)
    v = x.var(dim=axis, keepdim=True, unbiased=False)
    return (x - m) / torch.sqrt(v + eps)
def _scatter_add(tgt, idx, src, axis=0):
    return tgt.clone().index_add_(axis, idx, src)
def _segment_sum(src, seg, n):
    out = torch.zeros((n,) + src.shape[1:], dtype=src.dtype)
    return out.index_add_(0, seg, src)
def _pad(x, pw):
    flat = tuple(v for pair in reversed(pw) for v in pair)
    return torch.nn.functional.pad(x, flat)

kernel_name = 'gated_mix__grouped_kv_mqa__sliding_local_dilated__prompt'

def setup_inputs():

    _w = (lambda a: (lambda t: t.to(torch.bfloat16) if t.is_floating_point() else t)(torch.as_tensor(a)))
    def _A_setup():
        B, S, D, H = 1, 2048, 448, 16
        Dh = D // H
        return {
            "x": _w((lambda *s: torch.randn(*s, dtype=torch.bfloat16) * 0.05)(B, S, D)),
            "wq": _w((lambda *s: torch.randn(*s, dtype=torch.bfloat16) * 1.6)(D, H * Dh)),
            "wk": _w((lambda *s: torch.randn(*s, dtype=torch.bfloat16) * 1.6)(D, Dh)),
            "wv": _w((lambda *s: torch.randn(*s, dtype=torch.bfloat16) * 0.2)(D, Dh)),
            "wo": _w((lambda *s: torch.randn(*s, dtype=torch.bfloat16) * 0.2)(H * Dh, D)),
        }
    _A_in = _A_setup()

    def _B_setup():
        B, S, D = 1, 2048, 448
        return {
            "x": _w((lambda *s: torch.randn(*s, dtype=torch.bfloat16) * 0.05)(B, S, D)),
            "wqkv": _w((lambda *s: torch.randn(*s, dtype=torch.bfloat16) * 0.8)(D, 3 * D)),
            "wo": _w((lambda *s: torch.randn(*s, dtype=torch.bfloat16) * 0.05)(D, D)),
        }
    _B_in = _B_setup()

    return {
        "A_x": _A_in["x"],
        "A_wq": _A_in["wq"],
        "A_wk": _A_in["wk"],
        "A_wv": _A_in["wv"],
        "A_wo": _A_in["wo"],
        "B_x": _B_in["x"],
        "B_wqkv": _B_in["wqkv"],
        "B_wo": _B_in["wo"],
        "gate_w": _w((lambda *s: torch.randn(*s, dtype=torch.bfloat16) * 0.05)(448) * 16.0),
    }

def reference(A_x, A_wq, A_wk, A_wv, A_wo, B_x, B_wqkv, B_wo, gate_w):
    def _A_ref(x, wq, wk, wv, wo):
        B, S, D = x.shape
        H = 16
        Dh = D // H
        q = (lambda x, *d: x.permute(*d))((x @ wq).reshape(B, S, H, Dh), 0, 2, 1, 3)
        k = x @ wk
        v = x @ wv
        scores = torch.einsum("bhqd,bkd->bhqk", q, k) * (Dh ** -0.5)
        p = _softmax(scores, axis=-1)
        o = torch.einsum("bhqk,bkd->bhqd", p, v)
        return (lambda x, *d: x.permute(*d))(o, 0, 2, 1, 3).reshape(B, S, H * Dh) @ wo

    def _B_ref(x, wqkv, wo):
        B, S, D = x.shape
        H = 16; Dh = D // H
        W, dil = 8, 2
        qkv = (lambda x, *d: x.permute(*d))((x @ wqkv).reshape(B, S, 3, H, Dh), 2, 0, 3, 1, 4)
        q, k, v = qkv[0], qkv[1], qkv[2]
        scale = Dh ** -0.5
        pos = torch.arange(S)
        off = torch.arange(W) * dil
        idx = pos[:, None] - off[None, :]
        mask = idx >= 0
        idx_c = torch.where(mask, idx, 0).reshape(-1)
        kg = k[:, :, idx_c, :].reshape(B, H, S, W, Dh)
        vg = v[:, :, idx_c, :].reshape(B, H, S, W, Dh)
        logits = torch.einsum("bhsd,bhswd->bhsw", q, kg) * scale
        logits = torch.where(mask[None, None, :, :], logits, -1e9)
        attn = _softmax(logits, axis=-1)
        o = torch.einsum("bhsw,bhswd->bhsd", attn, vg)
        return (lambda x, *d: x.permute(*d))(o, 0, 2, 1, 3).reshape(B, S, D) @ wo

    x = A_x
    g = _sigmoid((x * gate_w).sum(-1, keepdims=True))
    a = _A_ref(x, A_wq, A_wk, A_wv, A_wo)
    b = _B_ref(x, B_wqkv, B_wo)
    return g * a + (1 - g) * b
```

```asm
; @launch kernel=k1_proj_kernel grid=(464,1,1) block=(256,1,1) lds=49152
; @launch kernel=k2_attn_kernel grid=(256,1,1) block=(512,1,1) lds=49152
; @launch kernel=k3_out_kernel grid=(224,1,1) block=(512,1,1) lds=65536
.amdgcn_target "amdgcn-amd-amdhsa--gfx950"
.text
.p2align 8
.globl k1_proj_kernel
.type k1_proj_kernel,@function
k1_proj_kernel:
    s_cmp_ge_u32 s2, 464
    s_cbranch_scc1 k1end_1
    s_load_dwordx2 s[20:21], s[0:1], 0
    s_load_dwordx2 s[22:23], s[0:1], 8
    s_load_dwordx2 s[24:25], s[0:1], 16
    s_load_dwordx2 s[26:27], s[0:1], 24
    s_load_dwordx2 s[28:29], s[0:1], 48
    s_load_dwordx2 s[30:31], s[0:1], 64
    s_load_dwordx2 s[32:33], s[0:1], 88
    s_mov_b32 s3, 148102321
    s_mul_hi_u32 s4, s2, s3
    s_mul_i32 s5, s4, 29
    s_sub_u32 s5, s2, s5
    v_and_b32 v1, 63, v0
    v_bfe_u32 v4, v0, 3, 5
    v_lshlrev_b32 v2, 7, v4
    v_bfe_u32 v4, v0, 4, 1
    v_lshlrev_b32 v4, 2, v4
    v_and_b32 v9, 7, v0
    v_xor_b32 v4, v4, v9
    v_lshl_add_u32 v2, v4, 4, v2
    v_lshrrev_b32 v4, 5, v1
    v_lshlrev_b32 v3, 3, v4
    v_bfe_u32 v4, v1, 2, 2
    v_add_u32 v3, v3, v4
    v_lshlrev_b32 v3, 7, v3
    v_bfe_u32 v4, v1, 4, 1
    v_lshl_add_u32 v3, v4, 5, v3
    v_and_b32 v4, 3, v1
    v_lshl_add_u32 v3, v4, 3, v3
    v_bfe_u32 v4, v1, 3, 1
    v_lshl_add_u32 v3, v4, 6, v3
    v_xor_b32 v11, 64, v3
    v_lshrrev_b32 v4, 6, v0
    v_lshlrev_b32 v7, 5, v4
    v_and_b32 v4, 31, v0
    v_add_u32 v7, v7, v4
    s_lshl_b32 s6, s4, 7
    v_add_u32 v7, s6, v7
    v_bfe_u32 v8, v0, 5, 1
    s_movk_i32 s7, 896
    v_mul_lo_u32 v5, v7, s7
    v_lshl_add_u32 v5, v8, 4, v5
    s_waitcnt lgkmcnt(0)
    s_mov_b32 s8, s20
    s_mov_b32 s9, s21
    s_mov_b32 s10, 1835008
    s_mov_b32 s11, 0x00020000
    v_lshrrev_b32 v4, 6, v0
    v_lshlrev_b32 v245, 5, v4
    v_and_b32 v4, 31, v0
    v_add_u32 v245, v245, v4
    v_bfe_u32 v4, v0, 3, 5
    v_and_b32 v9, 7, v4
    v_lshlrev_b32 v240, 7, v4
    v_and_b32 v4, 7, v0
    v_xor_b32 v4, v4, v9
    v_lshl_add_u32 v240, v4, 4, v240
    v_add_u32 v4, 0, v8
    v_and_b32 v9, 7, v245
    v_xor_b32 v4, v4, v9
    v_lshlrev_b32 v241, 7, v245
    v_lshl_add_u32 v241, v4, 4, v241
    v_add_u32 v4, 2, v8
    v_and_b32 v9, 7, v245
    v_xor_b32 v4, v4, v9
    v_lshlrev_b32 v242, 7, v245
    v_lshl_add_u32 v242, v4, 4, v242
    v_add_u32 v4, 4, v8
    v_and_b32 v9, 7, v245
    v_xor_b32 v4, v4, v9
    v_lshlrev_b32 v243, 7, v245
    v_lshl_add_u32 v243, v4, 4, v243
    v_add_u32 v4, 6, v8
    v_and_b32 v9, 7, v245
    v_xor_b32 v4, v4, v9
    v_lshlrev_b32 v244, 7, v245
    v_lshl_add_u32 v244, v4, 4, v244
    v_lshrrev_b32 v4, 3, v0
    v_add_u32 v4, s6, v4
    s_movk_i32 s7, 896
    v_mul_lo_u32 v246, v4, s7
    v_and_b32 v4, 7, v0
    v_lshl_add_u32 v246, v4, 4, v246
    s_cmp_eq_u32 s5, 28
    s_cbranch_scc1 k1spec_2
    s_cmp_ge_u32 s5, 7
    s_cbranch_scc1 k1qkv_3
    s_lshl_b32 s6, s5, 7
    s_add_u32 s12, s22, s6
    s_addc_u32 s13, s23, 0
    s_sub_u32 s14, 401408, s6
    s_mov_b32 s15, 0x00020000
    v_lshrrev_b32 v4, 3, v0
    s_movk_i32 s7, 896
    v_mul_lo_u32 v6, v4, s7
    v_and_b32 v4, 7, v0
    v_lshl_add_u32 v6, v4, 4, v6
    s_mov_b32 s40, 0
    buffer_load_dwordx4 v[120:123], v246, s[8:11], s40 offen offset:0
    s_mov_b32 s40, 28672
    buffer_load_dwordx4 v[124:127], v246, s[8:11], s40 offen offset:0
    s_mov_b32 s40, 57344
    buffer_load_dwordx4 v[128:131], v246, s[8:11], s40 offen offset:0
    s_mov_b32 s40, 86016
    buffer_load_dwordx4 v[132:135], v246, s[8:11], s40 offen offset:0
    s_mov_b32 s41, 0
    buffer_load_dwordx4 v[64:67], v6, s[12:15], s41 offen
    s_mov_b32 s41, 28672
    buffer_load_dwordx4 v[68:71], v6, s[12:15], s41 offen
    s_mov_b32 s40, 0
    buffer_load_dwordx4 v[136:139], v246, s[8:11], s40 offen offset:128
    s_mov_b32 s40, 28672
    buffer_load_dwordx4 v[140:143], v246, s[8:11], s40 offen offset:128
    s_mov_b32 s40, 57344
    buffer_load_dwordx4 v[144:147], v246, s[8:11], s40 offen offset:128
    s_mov_b32 s40, 86016
    buffer_load_dwordx4 v[148:151], v246, s[8:11], s40 offen offset:128
    s_mov_b32 s41, 57344
    buffer_load_dwordx4 v[72:75], v6, s[12:15], s41 offen
    s_mov_b32 s41, 86016
    buffer_load_dwordx4 v[76:79], v6, s[12:15], s41 offen
    s_mov_b32 s40, 0
    buffer_load_dwordx4 v[152:155], v246, s[8:11], s40 offen offset:256
    s_mov_b32 s40, 28672
    buffer_load_dwordx4 v[156:159], v246, s[8:11], s40 offen offset:256
    s_mov_b32 s40, 57344
    buffer_load_dwordx4 v[160:163], v246, s[8:11], s40 offen offset:256
    s_mov_b32 s40, 86016
    buffer_load_dwordx4 v[164:167], v246, s[8:11], s40 offen offset:256
    s_mov_b32 s41, 114688
    buffer_load_dwordx4 v[80:83], v6, s[12:15], s41 offen
    s_mov_b32 s41, 143360
    buffer_load_dwordx4 v[84:87], v6, s[12:15], s41 offen
    s_mov_b32 s40, 0
    buffer_load_dwordx4 v[168:171], v246, s[8:11], s40 offen offset:384
    s_mov_b32 s40, 28672
    buffer_load_dwordx4 v[172:175], v246, s[8:11], s40 offen offset:384
    s_mov_b32 s40, 57344
    buffer_load_dwordx4 v[176:179], v246, s[8:11], s40 offen offset:384
    s_mov_b32 s40, 86016
    buffer_load_dwordx4 v[180:183], v246, s[8:11], s40 offen offset:384
    s_mov_b32 s41, 172032
    buffer_load_dwordx4 v[88:91], v6, s[12:15], s41 offen
    s_mov_b32 s41, 200704
    buffer_load_dwordx4 v[92:95], v6, s[12:15], s41 offen
    s_mov_b32 s40, 0
    buffer_load_dwordx4 v[184:187], v246, s[8:11], s40 offen offset:512
    s_mov_b32 s40, 28672
    buffer_load_dwordx4 v[188:191], v246, s[8:11], s40 offen offset:512
    s_mov_b32 s40, 57344
    buffer_load_dwordx4 v[192:195], v246, s[8:11], s40 offen offset:512
    s_mov_b32 s40, 86016
    buffer_load_dwordx4 v[196:199], v246, s[8:11], s40 offen offset:512
    s_mov_b32 s41, 229376
    buffer_load_dwordx4 v[96:99], v6, s[12:15], s41 offen
    s_mov_b32 s41, 258048
    buffer_load_dwordx4 v[100:103], v6, s[12:15], s41 offen
    s_mov_b32 s40, 0
    buffer_load_dwordx4 v[200:203], v246, s[8:11], s40 offen offset:640
    s_mov_b32 s40, 28672
    buffer_load_dwordx4 v[204:207], v246, s[8:11], s40 offen offset:640
    s_mov_b32 s40, 57344
    buffer_load_dwordx4 v[208:211], v246, s[8:11], s40 offen offset:640
    s_mov_b32 s40, 86016
    buffer_load_dwordx4 v[212:215], v246, s[8:11], s40 offen offset:640
    s_mov_b32 s41, 286720
    buffer_load_dwordx4 v[104:107], v6, s[12:15], s41 offen
    s_mov_b32 s41, 315392
    buffer_load_dwordx4 v[108:111], v6, s[12:15], s41 offen
    s_mov_b32 s40, 0
    buffer_load_dwordx4 v[216:219], v246, s[8:11], s40 offen offset:768
    s_mov_b32 s40, 28672
    buffer_load_dwordx4 v[220:223], v246, s[8:11], s40 offen offset:768
    s_mov_b32 s40, 57344
    buffer_load_dwordx4 v[224:227], v246, s[8:11], s40 offen offset:768
    s_mov_b32 s40, 86016
    buffer_load_dwordx4 v[228:231], v246, s[8:11], s40 offen offset:768
    s_mov_b32 s41, 344064
    buffer_load_dwordx4 v[112:115], v6, s[12:15], s41 offen
    s_mov_b32 s41, 372736
    buffer_load_dwordx4 v[116:119], v6, s[12:15], s41 offen
    v_mov_b32 v16, 0
    v_mov_b32 v17, 0
    v_mov_b32 v18, 0
    v_mov_b32 v19, 0
    v_mov_b32 v20, 0
    v_mov_b32 v21, 0
    v_mov_b32 v22, 0
    v_mov_b32 v23, 0
    v_mov_b32 v24, 0
    v_mov_b32 v25, 0
    v_mov_b32 v26, 0
    v_mov_b32 v27, 0
    v_mov_b32 v28, 0
    v_mov_b32 v29, 0
    v_mov_b32 v30, 0
    v_mov_b32 v31, 0
    v_mov_b32 v32, 0
    v_mov_b32 v33, 0
    v_mov_b32 v34, 0
    v_mov_b32 v35, 0
    v_mov_b32 v36, 0
    v_mov_b32 v37, 0
    v_mov_b32 v38, 0
    v_mov_b32 v39, 0
    v_mov_b32 v40, 0
    v_mov_b32 v41, 0
    v_mov_b32 v42, 0
    v_mov_b32 v43, 0
    v_mov_b32 v44, 0
    v_mov_b32 v45, 0
    v_mov_b32 v46, 0
    v_mov_b32 v47, 0
    s_waitcnt vmcnt(36)
    ds_write_b128 v2, v[64:67] offset:16384
    ds_write_b128 v2, v[68:71] offset:20480
    ds_write_b128 v240, v[120:123] offset:0
    ds_write_b128 v240, v[124:127] offset:4096
    ds_write_b128 v240, v[128:131] offset:8192
    ds_write_b128 v240, v[132:135] offset:12288
    s_waitcnt lgkmcnt(0)
    s_barrier
    ds_read_b64_tr_b16 v[48:49], v3 offset:16384
    ds_read_b64_tr_b16 v[50:51], v3 offset:16896
    ds_read_b64_tr_b16 v[52:53], v11 offset:16384
    ds_read_b64_tr_b16 v[54:55], v11 offset:16896
    ds_read_b128 v[232:235], v241 offset:0
    s_waitcnt vmcnt(30)
    ds_write_b128 v2, v[72:75] offset:40960
    ds_write_b128 v2, v[76:79] offset:45056
    ds_write_b128 v240, v[136:139] offset:24576
    ds_write_b128 v240, v[140:143] offset:28672
    ds_write_b128 v240, v[144:147] offset:32768
    ds_write_b128 v240, v[148:151] offset:36864
    ds_read_b64_tr_b16 v[56:57], v3 offset:18432
    ds_read_b64_tr_b16 v[58:59], v3 offset:18944
    ds_read_b64_tr_b16 v[60:61], v11 offset:18432
    ds_read_b64_tr_b16 v[62:63], v11 offset:18944
    ds_read_b128 v[236:239], v242 offset:0
    s_waitcnt lgkmcnt(5)
    v_mfma_f32_32x32x16_bf16 v[16:31], v[48:51], v[232:235], v[16:31]
    v_mfma_f32_32x32x16_bf16 v[32:47], v[52:55], v[232:235], v[32:47]
    ds_read_b64_tr_b16 v[48:49], v3 offset:20480
    ds_read_b64_tr_b16 v[50:51], v3 offset:20992
    ds_read_b64_tr_b16 v[52:53], v11 offset:20480
    ds_read_b64_tr_b16 v[54:55], v11 offset:20992
    ds_read_b128 v[232:235], v243 offset:0
    s_waitcnt lgkmcnt(5)
    v_mfma_f32_32x32x16_bf16 v[16:31], v[56:59], v[236:239], v[16:31]
    v_mfma_f32_32x32x16_bf16 v[32:47], v[60:63], v[236:239], v[32:47]
    ds_read_b64_tr_b16 v[56:57], v3 offset:22528
    ds_read_b64_tr_b16 v[58:59], v3 offset:23040
    ds_read_b64_tr_b16 v[60:61], v11 offset:22528
    ds_read_b64_tr_b16 v[62:63], v11 offset:23040
    ds_read_b128 v[236:239], v244 offset:0
    s_waitcnt lgkmcnt(5)
    v_mfma_f32_32x32x16_bf16 v[16:31], v[48:51], v[232:235], v[16:31]
    v_mfma_f32_32x32x16_bf16 v[32:47], v[52:55], v[232:235], v[32:47]
    s_waitcnt lgkmcnt(0)
    v_mfma_f32_32x32x16_bf16 v[16:31], v[56:59], v[236:239], v[16:31]
    v_mfma_f32_32x32x16_bf16 v[32:47], v[60:63], v[236:239], v[32:47]
    s_barrier
    ds_read_b64_tr_b16 v[48:49], v3 offset:40960
    ds_read_b64_tr_b16 v[50:51], v3 offset:41472
    ds_read_b64_tr_b16 v[52:53], v11 offset:40960
    ds_read_b64_tr_b16 v[54:55], v11 offset:41472
    ds_read_b128 v[232:235], v241 offset:24576
    s_waitcnt vmcnt(24)
    ds_write_b128 v2, v[80:83] offset:16384
    ds_write_b128 v2, v[84:87] offset:20480
    ds_write_b128 v240, v[152:155] offset:0
    ds_write_b128 v240, v[156:159] offset:4096
    ds_write_b128 v240, v[160:163] offset:8192
    ds_write_b128 v240, v[164:167] offset:12288
    ds_read_b64_tr_b16 v[56:57], v3 offset:43008
    ds_read_b64_tr_b16 v[58:59], v3 offset:43520
    ds_read_b64_tr_b16 v[60:61], v11 offset:43008
    ds_read_b64_tr_b16 v[62:63], v11 offset:43520
    ds_read_b128 v[236:239], v242 offset:24576
    s_waitcnt lgkmcnt(5)
    v_mfma_f32_32x32x16_bf16 v[16:31], v[48:51], v[232:235], v[16:31]
    v_mfma_f32_32x32x16_bf16 v[32:47], v[52:55], v[232:235], v[32:47]
    ds_read_b64_tr_b16 v[48:49], v3 offset:45056
    ds_read_b64_tr_b16 v[50:51], v3 offset:45568
    ds_read_b64_tr_b16 v[52:53], v11 offset:45056
    ds_read_b64_tr_b16 v[54:55], v11 offset:45568
    ds_read_b128 v[232:235], v243 offset:24576
    s_waitcnt lgkmcnt(5)
    v_mfma_f32_32x32x16_bf16 v[16:31], v[56:59], v[236:239], v[16:31]
    v_mfma_f32_32x32x16_bf16 v[32:47], v[60:63], v[236:239], v[32:47]
    ds_read_b64_tr_b16 v[56:57], v3 offset:47104
    ds_read_b64_tr_b16 v[58:59], v3 offset:47616
    ds_read_b64_tr_b16 v[60:61], v11 offset:47104
    ds_read_b64_tr_b16 v[62:63], v11 offset:47616
    ds_read_b128 v[236:239], v244 offset:24576
    s_waitcnt lgkmcnt(5)
    v_mfma_f32_32x32x16_bf16 v[16:31], v[48:51], v[232:235], v[16:31]
    v_mfma_f32_32x32x16_bf16 v[32:47], v[52:55], v[232:235], v[32:47]
    s_waitcnt lgkmcnt(0)
    v_mfma_f32_32x32x16_bf16 v[16:31], v[56:59], v[236:239], v[16:31]
    v_mfma_f32_32x32x16_bf16 v[32:47], v[60:63], v[236:239], v[32:47]
    s_barrier
    ds_read_b64_tr_b16 v[48:49], v3 offset:16384
    ds_read_b64_tr_b16 v[50:51], v3 offset:16896
    ds_read_b64_tr_b16 v[52:53], v11 offset:16384
    ds_read_b64_tr_b16 v[54:55], v11 offset:16896
    ds_read_b128 v[232:235], v241 offset:0
    s_waitcnt vmcnt(18)
    ds_write_b128 v2, v[88:91] offset:40960
    ds_write_b128 v2, v[92:95] offset:45056
    ds_write_b128 v240, v[168:171] offset:24576
    ds_write_b128 v240, v[172:175] offset:28672
    ds_write_b128 v240, v[176:179] offset:32768
    ds_write_b128 v240, v[180:183] offset:36864
    ds_read_b64_tr_b16 v[56:57], v3 offset:18432
    ds_read_b64_tr_b16 v[58:59], v3 offset:18944
    ds_read_b64_tr_b16 v[60:61], v11 offset:18432
    ds_read_b64_tr_b16 v[62:63], v11 offset:18944
    ds_read_b128 v[236:239], v242 offset:0
    s_waitcnt lgkmcnt(5)
    v_mfma_f32_32x32x16_bf16 v[16:31], v[48:51], v[232:235], v[16:31]
    v_mfma_f32_32x32x16_bf16 v[32:47], v[52:55], v[232:235], v[32:47]
    ds_read_b64_tr_b16 v[48:49], v3 offset:20480
    ds_read_b64_tr_b16 v[50:51], v3 offset:20992
    ds_read_b64_tr_b16 v[52:53], v11 offset:20480
    ds_read_b64_tr_b16 v[54:55], v11 offset:20992
    ds_read_b128 v[232:235], v243 offset:0
    s_waitcnt lgkmcnt(5)
    v_mfma_f32_32x32x16_bf16 v[16:31], v[56:59], v[236:239], v[16:31]
    v_mfma_f32_32x32x16_bf16 v[32:47], v[60:63], v[236:239], v[32:47]
    ds_read_b64_tr_b16 v[56:57], v3 offset:22528
    ds_read_b64_tr_b16 v[58:59], v3 offset:23040
    ds_read_b64_tr_b16 v[60:61], v11 offset:22528
    ds_read_b64_tr_b16 v[62:63], v11 offset:23040
    ds_read_b128 v[236:239], v244 offset:0
    s_waitcnt lgkmcnt(5)
    v_mfma_f32_32x32x16_bf16 v[16:31], v[48:51], v[232:235], v[16:31]
    v_mfma_f32_32x32x16_bf16 v[32:47], v[52:55], v[232:235], v[32:47]
    s_waitcnt lgkmcnt(0)
    v_mfma_f32_32x32x16_bf16 v[16:31], v[56:59], v[236:239], v[16:31]
    v_mfma_f32_32x32x16_bf16 v[32:47], v[60:63], v[236:239], v[32:47]
    s_barrier
    ds_read_b64_tr_b16 v[48:49], v3 offset:40960
    ds_read_b64_tr_b16 v[50:51], v3 offset:41472
    ds_read_b64_tr_b16 v[52:53], v11 offset:40960
    ds_read_b64_tr_b16 v[54:55], v11 offset:41472
    ds_read_b128 v[232:235], v241 offset:24576
    s_waitcnt vmcnt(12)
    ds_write_b128 v2, v[96:99] offset:16384
    ds_write_b128 v2, v[100:103] offset:20480
    ds_write_b128 v240, v[184:187] offset:0
    ds_write_b128 v240, v[188:191] offset:4096
    ds_write_b128 v240, v[192:195] offset:8192
    ds_write_b128 v240, v[196:199] offset:12288
    ds_read_b64_tr_b16 v[56:57], v3 offset:43008
    ds_read_b64_tr_b16 v[58:59], v3 offset:43520
    ds_read_b64_tr_b16 v[60:61], v11 offset:43008
    ds_read_b64_tr_b16 v[62:63], v11 offset:43520
    ds_read_b128 v[236:239], v242 offset:24576
    s_waitcnt lgkmcnt(5)
    v_mfma_f32_32x32x16_bf16 v[16:31], v[48:51], v[232:235], v[16:31]
    v_mfma_f32_32x32x16_bf16 v[32:47], v[52:55], v[232:235], v[32:47]
    ds_read_b64_tr_b16 v[48:49], v3 offset:45056
    ds_read_b64_tr_b16 v[50:51], v3 offset:45568
    ds_read_b64_tr_b16 v[52:53], v11 offset:45056
    ds_read_b64_tr_b16 v[54:55], v11 offset:45568
    ds_read_b128 v[232:235], v243 offset:24576
    s_waitcnt lgkmcnt(5)
    v_mfma_f32_32x32x16_bf16 v[16:31], v[56:59], v[236:239], v[16:31]
    v_mfma_f32_32x32x16_bf16 v[32:47], v[60:63], v[236:239], v[32:47]
    ds_read_b64_tr_b16 v[56:57], v3 offset:47104
    ds_read_b64_tr_b16 v[58:59], v3 offset:47616
    ds_read_b64_tr_b16 v[60:61], v11 offset:47104
    ds_read_b64_tr_b16 v[62:63], v11 offset:47616
    ds_read_b128 v[236:239], v244 offset:24576
    s_waitcnt lgkmcnt(5)
    v_mfma_f32_32x32x16_bf16 v[16:31], v[48:51], v[232:235], v[16:31]
    v_mfma_f32_32x32x16_bf16 v[32:47], v[52:55], v[232:235], v[32:47]
    s_waitcnt lgkmcnt(0)
    v_mfma_f32_32x32x16_bf16 v[16:31], v[56:59], v[236:239], v[16:31]
    v_mfma_f32_32x32x16_bf16 v[32:47], v[60:63], v[236:239], v[32:47]
    s_barrier
    ds_read_b64_tr_b16 v[48:49], v3 offset:16384
    ds_read_b64_tr_b16 v[50:51], v3 offset:16896
    ds_read_b64_tr_b16 v[52:53], v11 offset:16384
    ds_read_b64_tr_b16 v[54:55], v11 offset:16896
    ds_read_b128 v[232:235], v241 offset:0
    s_waitcnt vmcnt(6)
    ds_write_b128 v2, v[104:107] offset:40960
    ds_write_b128 v2, v[108:111] offset:45056
    ds_write_b128 v240, v[200:203] offset:24576
    ds_write_b128 v240, v[204:207] offset:28672
    ds_write_b128 v240, v[208:211] offset:32768
    ds_write_b128 v240, v[212:215] offset:36864
    ds_read_b64_tr_b16 v[56:57], v3 offset:18432
    ds_read_b64_tr_b16 v[58:59], v3 offset:18944
    ds_read_b64_tr_b16 v[60:61], v11 offset:18432
    ds_read_b64_tr_b16 v[62:63], v11 offset:18944
    ds_read_b128 v[236:239], v242 offset:0
    s_waitcnt lgkmcnt(5)
    v_mfma_f32_32x32x16_bf16 v[16:31], v[48:51], v[232:235], v[16:31]
    v_mfma_f32_32x32x16_bf16 v[32:47], v[52:55], v[232:235], v[32:47]
    ds_read_b64_tr_b16 v[48:49], v3 offset:20480
    ds_read_b64_tr_b16 v[50:51], v3 offset:20992
    ds_read_b64_tr_b16 v[52:53], v11 offset:20480
    ds_read_b64_tr_b16 v[54:55], v11 offset:20992
    ds_read_b128 v[232:235], v243 offset:0
    s_waitcnt lgkmcnt(5)
    v_mfma_f32_32x32x16_bf16 v[16:31], v[56:59], v[236:239], v[16:31]
    v_mfma_f32_32x32x16_bf16 v[32:47], v[60:63], v[236:239], v[32:47]
    ds_read_b64_tr_b16 v[56:57], v3 offset:22528
    ds_read_b64_tr_b16 v[58:59], v3 offset:23040
    ds_read_b64_tr_b16 v[60:61], v11 offset:22528
    ds_read_b64_tr_b16 v[62:63], v11 offset:23040
    ds_read_b128 v[236:239], v244 offset:0
    s_waitcnt lgkmcnt(5)
    v_mfma_f32_32x32x16_bf16 v[16:31], v[48:51], v[232:235], v[16:31]
    v_mfma_f32_32x32x16_bf16 v[32:47], v[52:55], v[232:235], v[32:47]
    s_waitcnt lgkmcnt(0)
    v_mfma_f32_32x32x16_bf16 v[16:31], v[56:59], v[236:239], v[16:31]
    v_mfma_f32_32x32x16_bf16 v[32:47], v[60:63], v[236:239], v[32:47]
    s_barrier
    ds_read_b64_tr_b16 v[48:49], v3 offset:40960
    ds_read_b64_tr_b16 v[50:51], v3 offset:41472
    ds_read_b64_tr_b16 v[52:53], v11 offset:40960
    ds_read_b64_tr_b16 v[54:55], v11 offset:41472
    ds_read_b128 v[232:235], v241 offset:24576
    s_waitcnt vmcnt(0)
    ds_write_b128 v2, v[112:115] offset:16384
    ds_write_b128 v2, v[116:119] offset:20480
    ds_write_b128 v240, v[216:219] offset:0
    ds_write_b128 v240, v[220:223] offset:4096
    ds_write_b128 v240, v[224:227] offset:8192
    ds_write_b128 v240, v[228:231] offset:12288
    ds_read_b64_tr_b16 v[56:57], v3 offset:43008
    ds_read_b64_tr_b16 v[58:59], v3 offset:43520
    ds_read_b64_tr_b16 v[60:61], v11 offset:43008
    ds_read_b64_tr_b16 v[62:63], v11 offset:43520
    ds_read_b128 v[236:239], v242 offset:24576
    s_waitcnt lgkmcnt(5)
    v_mfma_f32_32x32x16_bf16 v[16:31], v[48:51], v[232:235], v[16:31]
    v_mfma_f32_32x32x16_bf16 v[32:47], v[52:55], v[232:235], v[32:47]
    ds_read_b64_tr_b16 v[48:49], v3 offset:45056
    ds_read_b64_tr_b16 v[50:51], v3 offset:45568
    ds_read_b64_tr_b16 v[52:53], v11 offset:45056
    ds_read_b64_tr_b16 v[54:55], v11 offset:45568
    ds_read_b128 v[232:235], v243 offset:24576
    s_waitcnt lgkmcnt(5)
    v_mfma_f32_32x32x16_bf16 v[16:31], v[56:59], v[236:239], v[16:31]
    v_mfma_f32_32x32x16_bf16 v[32:47], v[60:63], v[236:239], v[32:47]
    ds_read_b64_tr_b16 v[56:57], v3 offset:47104
    ds_read_b64_tr_b16 v[58:59], v3 offset:47616
    ds_read_b64_tr_b16 v[60:61], v11 offset:47104
    ds_read_b64_tr_b16 v[62:63], v11 offset:47616
    ds_read_b128 v[236:239], v244 offset:24576
    s_waitcnt lgkmcnt(5)
    v_mfma_f32_32x32x16_bf16 v[16:31], v[48:51], v[232:235], v[16:31]
    v_mfma_f32_32x32x16_bf16 v[32:47], v[52:55], v[232:235], v[32:47]
    s_waitcnt lgkmcnt(0)
    v_mfma_f32_32x32x16_bf16 v[16:31], v[56:59], v[236:239], v[16:31]
    v_mfma_f32_32x32x16_bf16 v[32:47], v[60:63], v[236:239], v[32:47]
    s_barrier
    ds_read_b64_tr_b16 v[48:49], v3 offset:16384
    ds_read_b64_tr_b16 v[50:51], v3 offset:16896
    ds_read_b64_tr_b16 v[52:53], v11 offset:16384
    ds_read_b64_tr_b16 v[54:55], v11 offset:16896
    ds_read_b128 v[232:235], v241 offset:0
    ds_read_b64_tr_b16 v[56:57], v3 offset:18432
    ds_read_b64_tr_b16 v[58:59], v3 offset:18944
    ds_read_b64_tr_b16 v[60:61], v11 offset:18432
    ds_read_b64_tr_b16 v[62:63], v11 offset:18944
    ds_read_b128 v[236:239], v242 offset:0
    s_waitcnt lgkmcnt(5)
    v_mfma_f32_32x32x16_bf16 v[16:31], v[48:51], v[232:235], v[16:31]
    v_mfma_f32_32x32x16_bf16 v[32:47], v[52:55], v[232:235], v[32:47]
    ds_read_b64_tr_b16 v[48:49], v3 offset:20480
    ds_read_b64_tr_b16 v[50:51], v3 offset:20992
    ds_read_b64_tr_b16 v[52:53], v11 offset:20480
    ds_read_b64_tr_b16 v[54:55], v11 offset:20992
    ds_read_b128 v[232:235], v243 offset:0
    s_waitcnt lgkmcnt(5)
    v_mfma_f32_32x32x16_bf16 v[16:31], v[56:59], v[236:239], v[16:31]
    v_mfma_f32_32x32x16_bf16 v[32:47], v[60:63], v[236:239], v[32:47]
    ds_read_b64_tr_b16 v[56:57], v3 offset:22528
    ds_read_b64_tr_b16 v[58:59], v3 offset:23040
    ds_read_b64_tr_b16 v[60:61], v11 offset:22528
    ds_read_b64_tr_b16 v[62:63], v11 offset:23040
    ds_read_b128 v[236:239], v244 offset:0
    s_waitcnt lgkmcnt(5)
    v_mfma_f32_32x32x16_bf16 v[16:31], v[48:51], v[232:235], v[16:31]
    v_mfma_f32_32x32x16_bf16 v[32:47], v[52:55], v[232:235], v[32:47]
    s_waitcnt lgkmcnt(0)
    v_mfma_f32_32x32x16_bf16 v[16:31], v[56:59], v[236:239], v[16:31]
    v_mfma_f32_32x32x16_bf16 v[32:47], v[60:63], v[236:239], v[32:47]
    s_nop 15
    s_nop 3
    s_mov_b32 s16, s32
    s_mov_b32 s17, s33
    s_mov_b32 s18, 2097152
    s_mov_b32 s19, 0x00020000
    s_lshl_b32 s6, s5, 4
    v_add_u32 v4, 0, v8
    v_add_u32 v4, s6, v4
    v_mul_u32_u24 v9, 147, v4
    v_lshrrev_b32 v9, 10, v9
    v_mul_u32_u24 v10, 7, v9
    v_sub_u32 v4, v4, v10
    v_lshlrev_b32 v10, 17, v9
    v_lshl_add_u32 v10, v7, 6, v10
    v_lshl_add_u32 v10, v4, 3, v10
    v_mul_f32 v16, 0x3e8b97f6, v16
    v_mul_f32 v17, 0x3e8b97f6, v17
    v_mul_f32 v18, 0x3e8b97f6, v18
    v_mul_f32 v19, 0x3e8b97f6, v19
    v_cvt_pk_bf16_f32 v12, v16, v17
    v_cvt_pk_bf16_f32 v13, v18, v19
    buffer_store_dwordx2 v[12:13], v10, s[16:19], 0 offen
    v_cmp_eq_u32 vcc, 6, v4
    v_mov_b32 v14, 0
    v_mov_b32 v15, 0
    s_and_saveexec_b64 s[36:37], vcc
    s_cbranch_execz k1z_4
    buffer_store_dwordx2 v[14:15], v10, s[16:19], 0 offen offset:8
k1z_4:
    s_mov_b64 exec, s[36:37]
    v_add_u32 v4, 2, v8
    v_add_u32 v4, s6, v4
    v_mul_u32_u24 v9, 147, v4
    v_lshrrev_b32 v9, 10, v9
    v_mul_u32_u24 v10, 7, v9
    v_sub_u32 v4, v4, v10
    v_lshlrev_b32 v10, 17, v9
    v_lshl_add_u32 v10, v7, 6, v10
    v_lshl_add_u32 v10, v4, 3, v10
    v_mul_f32 v20, 0x3e8b97f6, v20
    v_mul_f32 v21, 0x3e8b97f6, v21
    v_mul_f32 v22, 0x3e8b97f6, v22
    v_mul_f32 v23, 0x3e8b97f6, v23
    v_cvt_pk_bf16_f32 v12, v20, v21
    v_cvt_pk_bf16_f32 v13, v22, v23
    buffer_store_dwordx2 v[12:13], v10, s[16:19], 0 offen
    v_cmp_eq_u32 vcc, 6, v4
    v_mov_b32 v14, 0
    v_mov_b32 v15, 0
    s_and_saveexec_b64 s[36:37], vcc
    s_cbranch_execz k1z_5
    buffer_store_dwordx2 v[14:15], v10, s[16:19], 0 offen offset:8
k1z_5:
    s_mov_b64 exec, s[36:37]
    v_add_u32 v4, 4, v8
    v_add_u32 v4, s6, v4
    v_mul_u32_u24 v9, 147, v4
    v_lshrrev_b32 v9, 10, v9
    v_mul_u32_u24 v10, 7, v9
    v_sub_u32 v4, v4, v10
    v_lshlrev_b32 v10, 17, v9
    v_lshl_add_u32 v10, v7, 6, v10
    v_lshl_add_u32 v10, v4, 3, v10
    v_mul_f32 v24, 0x3e8b97f6, v24
    v_mul_f32 v25, 0x3e8b97f6, v25
    v_mul_f32 v26, 0x3e8b97f6, v26
    v_mul_f32 v27, 0x3e8b97f6, v27
    v_cvt_pk_bf16_f32 v12, v24, v25
    v_cvt_pk_bf16_f32 v13, v26, v27
    buffer_store_dwordx2 v[12:13], v10, s[16:19], 0 offen
    v_cmp_eq_u32 vcc, 6, v4
    v_mov_b32 v14, 0
    v_mov_b32 v15, 0
    s_and_saveexec_b64 s[36:37], vcc
    s_cbranch_execz k1z_6
    buffer_store_dwordx2 v[14:15], v10, s[16:19], 0 offen offset:8
k1z_6:
    s_mov_b64 exec, s[36:37]
    v_add_u32 v4, 6, v8
    v_add_u32 v4, s6, v4
    v_mul_u32_u24 v9, 147, v4
    v_lshrrev_b32 v9, 10, v9
    v_mul_u32_u24 v10, 7, v9
    v_sub_u32 v4, v4, v10
    v_lshlrev_b32 v10, 17, v9
    v_lshl_add_u32 v10, v7, 6, v10
    v_lshl_add_u32 v10, v4, 3, v10
    v_mul_f32 v28, 0x3e8b97f6, v28
    v_mul_f32 v29, 0x3e8b97f6, v29
    v_mul_f32 v30, 0x3e8b97f6, v30
    v_mul_f32 v31, 0x3e8b97f6, v31
    v_cvt_pk_bf16_f32 v12, v28, v29
    v_cvt_pk_bf16_f32 v13, v30, v31
    buffer_store_dwordx2 v[12:13], v10, s[16:19], 0 offen
    v_cmp_eq_u32 vcc, 6, v4
    v_mov_b32 v14, 0
    v_mov_b32 v15, 0
    s_and_saveexec_b64 s[36:37], vcc
    s_cbranch_execz k1z_7
    buffer_store_dwordx2 v[14:15], v10, s[16:19], 0 offen offset:8
k1z_7:
    s_mov_b64 exec, s[36:37]
    v_add_u32 v4, 8, v8
    v_add_u32 v4, s6, v4
    v_mul_u32_u24 v9, 147, v4
    v_lshrrev_b32 v9, 10, v9
    v_mul_u32_u24 v10, 7, v9
    v_sub_u32 v4, v4, v10
    v_lshlrev_b32 v10, 17, v9
    v_lshl_add_u32 v10, v7, 6, v10
    v_lshl_add_u32 v10, v4, 3, v10
    v_mul_f32 v32, 0x3e8b97f6, v32
    v_mul_f32 v33, 0x3e8b97f6, v33
    v_mul_f32 v34, 0x3e8b97f6, v34
    v_mul_f32 v35, 0x3e8b97f6, v35
    v_cvt_pk_bf16_f32 v12, v32, v33
    v_cvt_pk_bf16_f32 v13, v34, v35
    buffer_store_dwordx2 v[12:13], v10, s[16:19], 0 offen
    v_cmp_eq_u32 vcc, 6, v4
    v_mov_b32 v14, 0
    v_mov_b32 v15, 0
    s_and_saveexec_b64 s[36:37], vcc
    s_cbranch_execz k1z_8
    buffer_store_dwordx2 v[14:15], v10, s[16:19], 0 offen offset:8
k1z_8:
    s_mov_b64 exec, s[36:37]
    v_add_u32 v4, 10, v8
    v_add_u32 v4, s6, v4
    v_mul_u32_u24 v9, 147, v4
    v_lshrrev_b32 v9, 10, v9
    v_mul_u32_u24 v10, 7, v9
    v_sub_u32 v4, v4, v10
    v_lshlrev_b32 v10, 17, v9
    v_lshl_add_u32 v10, v7, 6, v10
    v_lshl_add_u32 v10, v4, 3, v10
    v_mul_f32 v36, 0x3e8b97f6, v36
    v_mul_f32 v37, 0x3e8b97f6, v37
    v_mul_f32 v38, 0x3e8b97f6, v38
    v_mul_f32 v39, 0x3e8b97f6, v39
    v_cvt_pk_bf16_f32 v12, v36, v37
    v_cvt_pk_bf16_f32 v13, v38, v39
    buffer_store_dwordx2 v[12:13], v10, s[16:19], 0 offen
    v_cmp_eq_u32 vcc, 6, v4
    v_mov_b32 v14, 0
    v_mov_b32 v15, 0
    s_and_saveexec_b64 s[36:37], vcc
    s_cbranch_execz k1z_9
    buffer_store_dwordx2 v[14:15], v10, s[16:19], 0 offen offset:8
k1z_9:
    s_mov_b64 exec, s[36:37]
    v_add_u32 v4, 12, v8
    v_add_u32 v4, s6, v4
    v_mul_u32_u24 v9, 147, v4
    v_lshrrev_b32 v9, 10, v9
    v_mul_u32_u24 v10, 7, v9
    v_sub_u32 v4, v4, v10
    v_lshlrev_b32 v10, 17, v9
    v_lshl_add_u32 v10, v7, 6, v10
    v_lshl_add_u32 v10, v4, 3, v10
    v_mul_f32 v40, 0x3e8b97f6, v40
    v_mul_f32 v41, 0x3e8b97f6, v41
    v_mul_f32 v42, 0x3e8b97f6, v42
    v_mul_f32 v43, 0x3e8b97f6, v43
    v_cvt_pk_bf16_f32 v12, v40, v41
    v_cvt_pk_bf16_f32 v13, v42, v43
    buffer_store_dwordx2 v[12:13], v10, s[16:19], 0 offen
    v_cmp_eq_u32 vcc, 6, v4
    v_mov_b32 v14, 0
    v_mov_b32 v15, 0
    s_and_saveexec_b64 s[36:37], vcc
    s_cbranch_execz k1z_10
    buffer_store_dwordx2 v[14:15], v10, s[16:19], 0 offen offset:8
k1z_10:
    s_mov_b64 exec, s[36:37]
    v_add_u32 v4, 14, v8
    v_add_u32 v4, s6, v4
    v_mul_u32_u24 v9, 147, v4
    v_lshrrev_b32 v9, 10, v9
    v_mul_u32_u24 v10, 7, v9
    v_sub_u32 v4, v4, v10
    v_lshlrev_b32 v10, 17, v9
    v_lshl_add_u32 v10, v7, 6, v10
    v_lshl_add_u32 v10, v4, 3, v10
    v_mul_f32 v44, 0x3e8b97f6, v44
    v_mul_f32 v45, 0x3e8b97f6, v45
    v_mul_f32 v46, 0x3e8b97f6, v46
    v_mul_f32 v47, 0x3e8b97f6, v47
    v_cvt_pk_bf16_f32 v12, v44, v45
    v_cvt_pk_bf16_f32 v13, v46, v47
    buffer_store_dwordx2 v[12:13], v10, s[16:19], 0 offen
    v_cmp_eq_u32 vcc, 6, v4
    v_mov_b32 v14, 0
    v_mov_b32 v15, 0
    s_and_saveexec_b64 s[36:37], vcc
    s_cbranch_execz k1z_11
    buffer_store_dwordx2 v[14:15], v10, s[16:19], 0 offen offset:8
k1z_11:
    s_mov_b64 exec, s[36:37]
    s_branch k1end_1
k1qkv_3:
    s_sub_u32 s6, s5, 7
    s_lshl_b32 s6, s6, 7
    s_add_u32 s12, s28, s6
    s_addc_u32 s13, s29, 0
    s_sub_u32 s14, 1204224, s6
    s_mov_b32 s15, 0x00020000
    v_lshrrev_b32 v4, 3, v0
    s_movk_i32 s7, 2688
    v_mul_lo_u32 v6, v4, s7
    v_and_b32 v4, 7, v0
    v_lshl_add_u32 v6, v4, 4, v6
    s_mov_b32 s40, 0
    buffer_load_dwordx4 v[120:123], v246, s[8:11], s40 offen offset:0
    s_mov_b32 s40, 28672
    buffer_load_dwordx4 v[124:127], v246, s[8:11], s40 offen offset:0
    s_mov_b32 s40, 57344
    buffer_load_dwordx4 v[128:131], v246, s[8:11], s40 offen offset:0
    s_mov_b32 s40, 86016
    buffer_load_dwordx4 v[132:135], v246, s[8:11], s40 offen offset:0
    s_mov_b32 s41, 0
    buffer_load_dwordx4 v[64:67], v6, s[12:15], s41 offen
    s_mov_b32 s41, 86016
    buffer_load_dwordx4 v[68:71], v6, s[12:15], s41 offen
    s_mov_b32 s40, 0
    buffer_load_dwordx4 v[136:139], v246, s[8:11], s40 offen offset:128
    s_mov_b32 s40, 28672
    buffer_load_dwordx4 v[140:143], v246, s[8:11], s40 offen offset:128
    s_mov_b32 s40, 57344
    buffer_load_dwordx4 v[144:147], v246, s[8:11], s40 offen offset:128
    s_mov_b32 s40, 86016
    buffer_load_dwordx4 v[148:151], v246, s[8:11], s40 offen offset:128
    s_mov_b32 s41, 172032
    buffer_load_dwordx4 v[72:75], v6, s[12:15], s41 offen
    s_mov_b32 s41, 258048
    buffer_load_dwordx4 v[76:79], v6, s[12:15], s41 offen
    s_mov_b32 s40, 0
    buffer_load_dwordx4 v[152:155], v246, s[8:11], s40 offen offset:256
    s_mov_b32 s40, 28672
    buffer_load_dwordx4 v[156:159], v246, s[8:11], s40 offen offset:256
    s_mov_b32 s40, 57344
    buffer_load_dwordx4 v[160:163], v246, s[8:11], s40 offen offset:256
    s_mov_b32 s40, 86016
    buffer_load_dwordx4 v[164:167], v246, s[8:11], s40 offen offset:256
    s_mov_b32 s41, 344064
    buffer_load_dwordx4 v[80:83], v6, s[12:15], s41 offen
    s_mov_b32 s41, 430080
    buffer_load_dwordx4 v[84:87], v6, s[12:15], s41 offen
    s_mov_b32 s40, 0
    buffer_load_dwordx4 v[168:171], v246, s[8:11], s40 offen offset:384
    s_mov_b32 s40, 28672
    buffer_load_dwordx4 v[172:175], v246, s[8:11], s40 offen offset:384
    s_mov_b32 s40, 57344
    buffer_load_dwordx4 v[176:179], v246, s[8:11], s40 offen offset:384
    s_mov_b32 s40, 86016
    buffer_load_dwordx4 v[180:183], v246, s[8:11], s40 offen offset:384
    s_mov_b32 s41, 516096
    buffer_load_dwordx4 v[88:91], v6, s[12:15], s41 offen
    s_mov_b32 s41, 602112
    buffer_load_dwordx4 v[92:95], v6, s[12:15], s41 offen
    s_mov_b32 s40, 0
    buffer_load_dwordx4 v[184:187], v246, s[8:11], s40 offen offset:512
    s_mov_b32 s40, 28672
    buffer_load_dwordx4 v[188:191], v246, s[8:11], s40 offen offset:512
    s_mov_b32 s40, 57344
    buffer_load_dwordx4 v[192:195], v246, s[8:11], s40 offen offset:512
    s_mov_b32 s40, 86016
    buffer_load_dwordx4 v[196:199], v246, s[8:11], s40 offen offset:512
    s_mov_b32 s41, 688128
    buffer_load_dwordx4 v[96:99], v6, s[12:15], s41 offen
    s_mov_b32 s41, 774144
    buffer_load_dwordx4 v[100:103], v6, s[12:15], s41 offen
    s_mov_b32 s40, 0
    buffer_load_dwordx4 v[200:203], v246, s[8:11], s40 offen offset:640
    s_mov_b32 s40, 28672
    buffer_load_dwordx4 v[204:207], v246, s[8:11], s40 offen offset:640
    s_mov_b32 s40, 57344
    buffer_load_dwordx4 v[208:211], v246, s[8:11], s40 offen offset:640
    s_mov_b32 s40, 86016
    buffer_load_dwordx4 v[212:215], v246, s[8:11], s40 offen offset:640
    s_mov_b32 s41, 860160
    buffer_load_dwordx4 v[104:107], v6, s[12:15], s41 offen
    s_mov_b32 s41, 946176
    buffer_load_dwordx4 v[108:111], v6, s[12:15], s41 offen
    s_mov_b32 s40, 0
    buffer_load_dwordx4 v[216:219], v246, s[8:11], s40 offen offset:768
    s_mov_b32 s40, 28672
    buffer_load_dwordx4 v[220:223], v246, s[8:11], s40 offen offset:768
    s_mov_b32 s40, 57344
    buffer_load_dwordx4 v[224:227], v246, s[8:11], s40 offen offset:768
    s_mov_b32 s40, 86016
    buffer_load_dwordx4 v[228:231], v246, s[8:11], s40 offen offset:768
    s_mov_b32 s41, 1032192
    buffer_load_dwordx4 v[112:115], v6, s[12:15], s41 offen
    s_mov_b32 s41, 1118208
    buffer_load_dwordx4 v[116:119], v6, s[12:15], s41 offen
    v_mov_b32 v16, 0
    v_mov_b32 v17, 0
    v_mov_b32 v18, 0
    v_mov_b32 v19, 0
    v_mov_b32 v20, 0
    v_mov_b32 v21, 0
    v_mov_b32 v22, 0
    v_mov_b32 v23, 0
    v_mov_b32 v24, 0
    v_mov_b32 v25, 0
    v_mov_b32 v26, 0
    v_mov_b32 v27, 0
    v_mov_b32 v28, 0
    v_mov_b32 v29, 0
    v_mov_b32 v30, 0
    v_mov_b32 v31, 0
    v_mov_b32 v32, 0
    v_mov_b32 v33, 0
    v_mov_b32 v34, 0
    v_mov_b32 v35, 0
    v_mov_b32 v36, 0
    v_mov_b32 v37, 0
    v_mov_b32 v38, 0
    v_mov_b32 v39, 0
    v_mov_b32 v40, 0
    v_mov_b32 v41, 0
    v_mov_b32 v42, 0
    v_mov_b32 v43, 0
    v_mov_b32 v44, 0
    v_mov_b32 v45, 0
    v_mov_b32 v46, 0
    v_mov_b32 v47, 0
    s_waitcnt vmcnt(36)
    ds_write_b128 v2, v[64:67] offset:16384
    ds_write_b128 v2, v[68:71] offset:20480
    ds_write_b128 v240, v[120:123] offset:0
    ds_write_b128 v240, v[124:127] offset:4096
    ds_write_b128 v240, v[128:131] offset:8192
    ds_write_b128 v240, v[132:135] offset:12288
    s_waitcnt lgkmcnt(0)
    s_barrier
    ds_read_b64_tr_b16 v[48:49], v3 offset:16384
    ds_read_b64_tr_b16 v[50:51], v3 offset:16896
    ds_read_b64_tr_b16 v[52:53], v11 offset:16384
    ds_read_b64_tr_b16 v[54:55], v11 offset:16896
    ds_read_b128 v[232:235], v241 offset:0
    s_waitcnt vmcnt(30)
    ds_write_b128 v2, v[72:75] offset:40960
    ds_write_b128 v2, v[76:79] offset:45056
    ds_write_b128 v240, v[136:139] offset:24576
    ds_write_b128 v240, v[140:143] offset:28672
    ds_write_b128 v240, v[144:147] offset:32768
    ds_write_b128 v240, v[148:151] offset:36864
    ds_read_b64_tr_b16 v[56:57], v3 offset:18432
    ds_read_b64_tr_b16 v[58:59], v3 offset:18944
    ds_read_b64_tr_b16 v[60:61], v11 offset:18432
    ds_read_b64_tr_b16 v[62:63], v11 offset:18944
    ds_read_b128 v[236:239], v242 offset:0
    s_waitcnt lgkmcnt(5)
    v_mfma_f32_32x32x16_bf16 v[16:31], v[48:51], v[232:235], v[16:31]
    v_mfma_f32_32x32x16_bf16 v[32:47], v[52:55], v[232:235], v[32:47]
    ds_read_b64_tr_b16 v[48:49], v3 offset:20480
    ds_read_b64_tr_b16 v[50:51], v3 offset:20992
    ds_read_b64_tr_b16 v[52:53], v11 offset:20480
    ds_read_b64_tr_b16 v[54:55], v11 offset:20992
    ds_read_b128 v[232:235], v243 offset:0
    s_waitcnt lgkmcnt(5)
    v_mfma_f32_32x32x16_bf16 v[16:31], v[56:59], v[236:239], v[16:31]
    v_mfma_f32_32x32x16_bf16 v[32:47], v[60:63], v[236:239], v[32:47]
    ds_read_b64_tr_b16 v[56:57], v3 offset:22528
    ds_read_b64_tr_b16 v[58:59], v3 offset:23040
    ds_read_b64_tr_b16 v[60:61], v11 offset:22528
    ds_read_b64_tr_b16 v[62:63], v11 offset:23040
    ds_read_b128 v[236:239], v244 offset:0
    s_waitcnt lgkmcnt(5)
    v_mfma_f32_32x32x16_bf16 v[16:31], v[48:51], v[232:235], v[16:31]
    v_mfma_f32_32x32x16_bf16 v[32:47], v[52:55], v[232:235], v[32:47]
    s_waitcnt lgkmcnt(0)
    v_mfma_f32_32x32x16_bf16 v[16:31], v[56:59], v[236:239], v[16:31]
    v_mfma_f32_32x32x16_bf16 v[32:47], v[60:63], v[236:239], v[32:47]
    s_barrier
    ds_read_b64_tr_b16 v[48:49], v3 offset:40960
    ds_read_b64_tr_b16 v[50:51], v3 offset:41472
    ds_read_b64_tr_b16 v[52:53], v11 offset:40960
    ds_read_b64_tr_b16 v[54:55], v11 offset:41472
    ds_read_b128 v[232:235], v241 offset:24576
    s_waitcnt vmcnt(24)
    ds_write_b128 v2, v[80:83] offset:16384
    ds_write_b128 v2, v[84:87] offset:20480
    ds_write_b128 v240, v[152:155] offset:0
    ds_write_b128 v240, v[156:159] offset:4096
    ds_write_b128 v240, v[160:163] offset:8192
    ds_write_b128 v240, v[164:167] offset:12288
    ds_read_b64_tr_b16 v[56:57], v3 offset:43008
    ds_read_b64_tr_b16 v[58:59], v3 offset:43520
    ds_read_b64_tr_b16 v[60:61], v11 offset:43008
    ds_read_b64_tr_b16 v[62:63], v11 offset:43520
    ds_read_b128 v[236:239], v242 offset:24576
    s_waitcnt lgkmcnt(5)
    v_mfma_f32_32x32x16_bf16 v[16:31], v[48:51], v[232:235], v[16:31]
    v_mfma_f32_32x32x16_bf16 v[32:47], v[52:55], v[232:235], v[32:47]
    ds_read_b64_tr_b16 v[48:49], v3 offset:45056
    ds_read_b64_tr_b16 v[50:51], v3 offset:45568
    ds_read_b64_tr_b16 v[52:53], v11 offset:45056
    ds_read_b64_tr_b16 v[54:55], v11 offset:45568
    ds_read_b128 v[232:235], v243 offset:24576
    s_waitcnt lgkmcnt(5)
    v_mfma_f32_32x32x16_bf16 v[16:31], v[56:59], v[236:239], v[16:31]
    v_mfma_f32_32x32x16_bf16 v[32:47], v[60:63], v[236:239], v[32:47]
    ds_read_b64_tr_b16 v[56:57], v3 offset:47104
    ds_read_b64_tr_b16 v[58:59], v3 offset:47616
    ds_read_b64_tr_b16 v[60:61], v11 offset:47104
    ds_read_b64_tr_b16 v[62:63], v11 offset:47616
    ds_read_b128 v[236:239], v244 offset:24576
    s_waitcnt lgkmcnt(5)
    v_mfma_f32_32x32x16_bf16 v[16:31], v[48:51], v[232:235], v[16:31]
    v_mfma_f32_32x32x16_bf16 v[32:47], v[52:55], v[232:235], v[32:47]
    s_waitcnt lgkmcnt(0)
    v_mfma_f32_32x32x16_bf16 v[16:31], v[56:59], v[236:239], v[16:31]
    v_mfma_f32_32x32x16_bf16 v[32:47], v[60:63], v[236:239], v[32:47]
    s_barrier
    ds_read_b64_tr_b16 v[48:49], v3 offset:16384
    ds_read_b64_tr_b16 v[50:51], v3 offset:16896
    ds_read_b64_tr_b16 v[52:53], v11 offset:16384
    ds_read_b64_tr_b16 v[54:55], v11 offset:16896
    ds_read_b128 v[232:235], v241 offset:0
    s_waitcnt vmcnt(18)
    ds_write_b128 v2, v[88:91] offset:40960
    ds_write_b128 v2, v[92:95] offset:45056
    ds_write_b128 v240, v[168:171] offset:24576
    ds_write_b128 v240, v[172:175] offset:28672
    ds_write_b128 v240, v[176:179] offset:32768
    ds_write_b128 v240, v[180:183] offset:36864
    ds_read_b64_tr_b16 v[56:57], v3 offset:18432
    ds_read_b64_tr_b16 v[58:59], v3 offset:18944
    ds_read_b64_tr_b16 v[60:61], v11 offset:18432
    ds_read_b64_tr_b16 v[62:63], v11 offset:18944
    ds_read_b128 v[236:239], v242 offset:0
    s_waitcnt lgkmcnt(5)
    v_mfma_f32_32x32x16_bf16 v[16:31], v[48:51], v[232:235], v[16:31]
    v_mfma_f32_32x32x16_bf16 v[32:47], v[52:55], v[232:235], v[32:47]
    ds_read_b64_tr_b16 v[48:49], v3 offset:20480
    ds_read_b64_tr_b16 v[50:51], v3 offset:20992
    ds_read_b64_tr_b16 v[52:53], v11 offset:20480
    ds_read_b64_tr_b16 v[54:55], v11 offset:20992
    ds_read_b128 v[232:235], v243 offset:0
    s_waitcnt lgkmcnt(5)
    v_mfma_f32_32x32x16_bf16 v[16:31], v[56:59], v[236:239], v[16:31]
    v_mfma_f32_32x32x16_bf16 v[32:47], v[60:63], v[236:239], v[32:47]
    ds_read_b64_tr_b16 v[56:57], v3 offset:22528
    ds_read_b64_tr_b16 v[58:59], v3 offset:23040
    ds_read_b64_tr_b16 v[60:61], v11 offset:22528
    ds_read_b64_tr_b16 v[62:63], v11 offset:23040
    ds_read_b128 v[236:239], v244 offset:0
    s_waitcnt lgkmcnt(5)
    v_mfma_f32_32x32x16_bf16 v[16:31], v[48:51], v[232:235], v[16:31]
    v_mfma_f32_32x32x16_bf16 v[32:47], v[52:55], v[232:235], v[32:47]
    s_waitcnt lgkmcnt(0)
    v_mfma_f32_32x32x16_bf16 v[16:31], v[56:59], v[236:239], v[16:31]
    v_mfma_f32_32x32x16_bf16 v[32:47], v[60:63], v[236:239], v[32:47]
    s_barrier
    ds_read_b64_tr_b16 v[48:49], v3 offset:40960
    ds_read_b64_tr_b16 v[50:51], v3 offset:41472
    ds_read_b64_tr_b16 v[52:53], v11 offset:40960
    ds_read_b64_tr_b16 v[54:55], v11 offset:41472
    ds_read_b128 v[232:235], v241 offset:24576
    s_waitcnt vmcnt(12)
    ds_write_b128 v2, v[96:99] offset:16384
    ds_write_b128 v2, v[100:103] offset:20480
    ds_write_b128 v240, v[184:187] offset:0
    ds_write_b128 v240, v[188:191] offset:4096
    ds_write_b128 v240, v[192:195] offset:8192
    ds_write_b128 v240, v[196:199] offset:12288
    ds_read_b64_tr_b16 v[56:57], v3 offset:43008
    ds_read_b64_tr_b16 v[58:59], v3 offset:43520
    ds_read_b64_tr_b16 v[60:61], v11 offset:43008
    ds_read_b64_tr_b16 v[62:63], v11 offset:43520
    ds_read_b128 v[236:239], v242 offset:24576
    s_waitcnt lgkmcnt(5)
    v_mfma_f32_32x32x16_bf16 v[16:31], v[48:51], v[232:235], v[16:31]
    v_mfma_f32_32x32x16_bf16 v[32:47], v[52:55], v[232:235], v[32:47]
    ds_read_b64_tr_b16 v[48:49], v3 offset:45056
    ds_read_b64_tr_b16 v[50:51], v3 offset:45568
    ds_read_b64_tr_b16 v[52:53], v11 offset:45056
    ds_read_b64_tr_b16 v[54:55], v11 offset:45568
    ds_read_b128 v[232:235], v243 offset:24576
    s_waitcnt lgkmcnt(5)
    v_mfma_f32_32x32x16_bf16 v[16:31], v[56:59], v[236:239], v[16:31]
    v_mfma_f32_32x32x16_bf16 v[32:47], v[60:63], v[236:239], v[32:47]
    ds_read_b64_tr_b16 v[56:57], v3 offset:47104
    ds_read_b64_tr_b16 v[58:59], v3 offset:47616
    ds_read_b64_tr_b16 v[60:61], v11 offset:47104
    ds_read_b64_tr_b16 v[62:63], v11 offset:47616
    ds_read_b128 v[236:239], v244 offset:24576
    s_waitcnt lgkmcnt(5)
    v_mfma_f32_32x32x16_bf16 v[16:31], v[48:51], v[232:235], v[16:31]
    v_mfma_f32_32x32x16_bf16 v[32:47], v[52:55], v[232:235], v[32:47]
    s_waitcnt lgkmcnt(0)
    v_mfma_f32_32x32x16_bf16 v[16:31], v[56:59], v[236:239], v[16:31]
    v_mfma_f32_32x32x16_bf16 v[32:47], v[60:63], v[236:239], v[32:47]
    s_barrier
    ds_read_b64_tr_b16 v[48:49], v3 offset:16384
    ds_read_b64_tr_b16 v[50:51], v3 offset:16896
    ds_read_b64_tr_b16 v[52:53], v11 offset:16384
    ds_read_b64_tr_b16 v[54:55], v11 offset:16896
    ds_read_b128 v[232:235], v241 offset:0
    s_waitcnt vmcnt(6)
    ds_write_b128 v2, v[104:107] offset:40960
    ds_write_b128 v2, v[108:111] offset:45056
    ds_write_b128 v240, v[200:203] offset:24576
    ds_write_b128 v240, v[204:207] offset:28672
    ds_write_b128 v240, v[208:211] offset:32768
    ds_write_b128 v240, v[212:215] offset:36864
    ds_read_b64_tr_b16 v[56:57], v3 offset:18432
    ds_read_b64_tr_b16 v[58:59], v3 offset:18944
    ds_read_b64_tr_b16 v[60:61], v11 offset:18432
    ds_read_b64_tr_b16 v[62:63], v11 offset:18944
    ds_read_b128 v[236:239], v242 offset:0
    s_waitcnt lgkmcnt(5)
    v_mfma_f32_32x32x16_bf16 v[16:31], v[48:51], v[232:235], v[16:31]
    v_mfma_f32_32x32x16_bf16 v[32:47], v[52:55], v[232:235], v[32:47]
    ds_read_b64_tr_b16 v[48:49], v3 offset:20480
    ds_read_b64_tr_b16 v[50:51], v3 offset:20992
    ds_read_b64_tr_b16 v[52:53], v11 offset:20480
    ds_read_b64_tr_b16 v[54:55], v11 offset:20992
    ds_read_b128 v[232:235], v243 offset:0
    s_waitcnt lgkmcnt(5)
    v_mfma_f32_32x32x16_bf16 v[16:31], v[56:59], v[236:239], v[16:31]
    v_mfma_f32_32x32x16_bf16 v[32:47], v[60:63], v[236:239], v[32:47]
    ds_read_b64_tr_b16 v[56:57], v3 offset:22528
    ds_read_b64_tr_b16 v[58:59], v3 offset:23040
    ds_read_b64_tr_b16 v[60:61], v11 offset:22528
    ds_read_b64_tr_b16 v[62:63], v11 offset:23040
    ds_read_b128 v[236:239], v244 offset:0
    s_waitcnt lgkmcnt(5)
    v_mfma_f32_32x32x16_bf16 v[16:31], v[48:51], v[232:235], v[16:31]
    v_mfma_f32_32x32x16_bf16 v[32:47], v[52:55], v[232:235], v[32:47]
    s_waitcnt lgkmcnt(0)
    v_mfma_f32_32x32x16_bf16 v[16:31], v[56:59], v[236:239], v[16:31]
    v_mfma_f32_32x32x16_bf16 v[32:47], v[60:63], v[236:239], v[32:47]
    s_barrier
    ds_read_b64_tr_b16 v[48:49], v3 offset:40960
    ds_read_b64_tr_b16 v[50:51], v3 offset:41472
    ds_read_b64_tr_b16 v[52:53], v11 offset:40960
    ds_read_b64_tr_b16 v[54:55], v11 offset:41472
    ds_read_b128 v[232:235], v241 offset:24576
    s_waitcnt vmcnt(0)
    ds_write_b128 v2, v[112:115] offset:16384
    ds_write_b128 v2, v[116:119] offset:20480
    ds_write_b128 v240, v[216:219] offset:0
    ds_write_b128 v240, v[220:223] offset:4096
    ds_write_b128 v240, v[224:227] offset:8192
    ds_write_b128 v240, v[228:231] offset:12288
    ds_read_b64_tr_b16 v[56:57], v3 offset:43008
    ds_read_b64_tr_b16 v[58:59], v3 offset:43520
    ds_read_b64_tr_b16 v[60:61], v11 offset:43008
    ds_read_b64_tr_b16 v[62:63], v11 offset:43520
    ds_read_b128 v[236:239], v242 offset:24576
    s_waitcnt lgkmcnt(5)
    v_mfma_f32_32x32x16_bf16 v[16:31], v[48:51], v[232:235], v[16:31]
    v_mfma_f32_32x32x16_bf16 v[32:47], v[52:55], v[232:235], v[32:47]
    ds_read_b64_tr_b16 v[48:49], v3 offset:45056
    ds_read_b64_tr_b16 v[50:51], v3 offset:45568
    ds_read_b64_tr_b16 v[52:53], v11 offset:45056
    ds_read_b64_tr_b16 v[54:55], v11 offset:45568
    ds_read_b128 v[232:235], v243 offset:24576
    s_waitcnt lgkmcnt(5)
    v_mfma_f32_32x32x16_bf16 v[16:31], v[56:59], v[236:239], v[16:31]
    v_mfma_f32_32x32x16_bf16 v[32:47], v[60:63], v[236:239], v[32:47]
    ds_read_b64_tr_b16 v[56:57], v3 offset:47104
    ds_read_b64_tr_b16 v[58:59], v3 offset:47616
    ds_read_b64_tr_b16 v[60:61], v11 offset:47104
    ds_read_b64_tr_b16 v[62:63], v11 offset:47616
    ds_read_b128 v[236:239], v244 offset:24576
    s_waitcnt lgkmcnt(5)
    v_mfma_f32_32x32x16_bf16 v[16:31], v[48:51], v[232:235], v[16:31]
    v_mfma_f32_32x32x16_bf16 v[32:47], v[52:55], v[232:235], v[32:47]
    s_waitcnt lgkmcnt(0)
    v_mfma_f32_32x32x16_bf16 v[16:31], v[56:59], v[236:239], v[16:31]
    v_mfma_f32_32x32x16_bf16 v[32:47], v[60:63], v[236:239], v[32:47]
    s_barrier
    ds_read_b64_tr_b16 v[48:49], v3 offset:16384
    ds_read_b64_tr_b16 v[50:51], v3 offset:16896
    ds_read_b64_tr_b16 v[52:53], v11 offset:16384
    ds_read_b64_tr_b16 v[54:55], v11 offset:16896
    ds_read_b128 v[232:235], v241 offset:0
    ds_read_b64_tr_b16 v[56:57], v3 offset:18432
    ds_read_b64_tr_b16 v[58:59], v3 offset:18944
    ds_read_b64_tr_b16 v[60:61], v11 offset:18432
    ds_read_b64_tr_b16 v[62:63], v11 offset:18944
    ds_read_b128 v[236:239], v242 offset:0
    s_waitcnt lgkmcnt(5)
    v_mfma_f32_32x32x16_bf16 v[16:31], v[48:51], v[232:235], v[16:31]
    v_mfma_f32_32x32x16_bf16 v[32:47], v[52:55], v[232:235], v[32:47]
    ds_read_b64_tr_b16 v[48:49], v3 offset:20480
    ds_read_b64_tr_b16 v[50:51], v3 offset:20992
    ds_read_b64_tr_b16 v[52:53], v11 offset:20480
    ds_read_b64_tr_b16 v[54:55], v11 offset:20992
    ds_read_b128 v[232:235], v243 offset:0
    s_waitcnt lgkmcnt(5)
    v_mfma_f32_32x32x16_bf16 v[16:31], v[56:59], v[236:239], v[16:31]
    v_mfma_f32_32x32x16_bf16 v[32:47], v[60:63], v[236:239], v[32:47]
    ds_read_b64_tr_b16 v[56:57], v3 offset:22528
    ds_read_b64_tr_b16 v[58:59], v3 offset:23040
    ds_read_b64_tr_b16 v[60:61], v11 offset:22528
    ds_read_b64_tr_b16 v[62:63], v11 offset:23040
    ds_read_b128 v[236:239], v244 offset:0
    s_waitcnt lgkmcnt(5)
    v_mfma_f32_32x32x16_bf16 v[16:31], v[48:51], v[232:235], v[16:31]
    v_mfma_f32_32x32x16_bf16 v[32:47], v[52:55], v[232:235], v[32:47]
    s_waitcnt lgkmcnt(0)
    v_mfma_f32_32x32x16_bf16 v[16:31], v[56:59], v[236:239], v[16:31]
    v_mfma_f32_32x32x16_bf16 v[32:47], v[60:63], v[236:239], v[32:47]
    s_nop 15
    s_nop 3
    s_add_u32 s16, s32, 3145728
    s_addc_u32 s17, s33, 0
    s_mov_b32 s18, 5505024
    s_mov_b32 s19, 0x00020000
    s_movk_i32 s7, 2688
    v_mul_lo_u32 v10, v7, s7
    v_lshl_add_u32 v10, v8, 3, v10
    v_add_u32 v10, s6, v10
    v_cvt_pk_bf16_f32 v12, v16, v17
    v_cvt_pk_bf16_f32 v13, v18, v19
    buffer_store_dwordx2 v[12:13], v10, s[16:19], 0 offen offset:0
    s_nop 0
    v_cvt_pk_bf16_f32 v12, v20, v21
    v_cvt_pk_bf16_f32 v13, v22, v23
    buffer_store_dwordx2 v[12:13], v10, s[16:19], 0 offen offset:16
    s_nop 0
    v_cvt_pk_bf16_f32 v12, v24, v25
    v_cvt_pk_bf16_f32 v13, v26, v27
    buffer_store_dwordx2 v[12:13], v10, s[16:19], 0 offen offset:32
    s_nop 0
    v_cvt_pk_bf16_f32 v12, v28, v29
    v_cvt_pk_bf16_f32 v13, v30, v31
    buffer_store_dwordx2 v[12:13], v10, s[16:19], 0 offen offset:48
    s_nop 0
    v_cvt_pk_bf16_f32 v12, v32, v33
    v_cvt_pk_bf16_f32 v13, v34, v35
    buffer_store_dwordx2 v[12:13], v10, s[16:19], 0 offen offset:64
    s_nop 0
    v_cvt_pk_bf16_f32 v12, v36, v37
    v_cvt_pk_bf16_f32 v13, v38, v39
    buffer_store_dwordx2 v[12:13], v10, s[16:19], 0 offen offset:80
    s_nop 0
    v_cvt_pk_bf16_f32 v12, v40, v41
    v_cvt_pk_bf16_f32 v13, v42, v43
    buffer_store_dwordx2 v[12:13], v10, s[16:19], 0 offen offset:96
    s_nop 0
    v_cvt_pk_bf16_f32 v12, v44, v45
    v_cvt_pk_bf16_f32 v13, v46, v47
    buffer_store_dwordx2 v[12:13], v10, s[16:19], 0 offen offset:112
    s_nop 0
    s_branch k1end_1
k1spec_2:
    s_mov_b32 s40, 0
    buffer_load_dwordx4 v[120:123], v246, s[8:11], s40 offen offset:0
    s_mov_b32 s40, 28672
    buffer_load_dwordx4 v[124:127], v246, s[8:11], s40 offen offset:0
    s_mov_b32 s40, 57344
    buffer_load_dwordx4 v[128:131], v246, s[8:11], s40 offen offset:0
    s_mov_b32 s40, 86016
    buffer_load_dwordx4 v[132:135], v246, s[8:11], s40 offen offset:0
    s_mov_b32 s40, 0
    buffer_load_dwordx4 v[136:139], v246, s[8:11], s40 offen offset:128
    s_mov_b32 s40, 28672
    buffer_load_dwordx4 v[140:143], v246, s[8:11], s40 offen offset:128
    s_mov_b32 s40, 57344
    buffer_load_dwordx4 v[144:147], v246, s[8:11], s40 offen offset:128
    s_mov_b32 s40, 86016
    buffer_load_dwordx4 v[148:151], v246, s[8:11], s40 offen offset:128
    s_mov_b32 s40, 0
    buffer_load_dwordx4 v[152:155], v246, s[8:11], s40 offen offset:256
    s_mov_b32 s40, 28672
    buffer_load_dwordx4 v[156:159], v246, s[8:11], s40 offen offset:256
    s_mov_b32 s40, 57344
    buffer_load_dwordx4 v[160:163], v246, s[8:11], s40 offen offset:256
    s_mov_b32 s40, 86016
    buffer_load_dwordx4 v[164:167], v246, s[8:11], s40 offen offset:256
    s_mov_b32 s40, 0
    buffer_load_dwordx4 v[168:171], v246, s[8:11], s40 offen offset:384
    s_mov_b32 s40, 28672
    buffer_load_dwordx4 v[172:175], v246, s[8:11], s40 offen offset:384
    s_mov_b32 s40, 57344
    buffer_load_dwordx4 v[176:179], v246, s[8:11], s40 offen offset:384
    s_mov_b32 s40, 86016
    buffer_load_dwordx4 v[180:183], v246, s[8:11], s40 offen offset:384
    s_mov_b32 s40, 0
    buffer_load_dwordx4 v[184:187], v246, s[8:11], s40 offen offset:512
    s_mov_b32 s40, 28672
    buffer_load_dwordx4 v[188:191], v246, s[8:11], s40 offen offset:512
    s_mov_b32 s40, 57344
    buffer_load_dwordx4 v[192:195], v246, s[8:11], s40 offen offset:512
    s_mov_b32 s40, 86016
    buffer_load_dwordx4 v[196:199], v246, s[8:11], s40 offen offset:512
    s_mov_b32 s40, 0
    buffer_load_dwordx4 v[200:203], v246, s[8:11], s40 offen offset:640
    s_mov_b32 s40, 28672
    buffer_load_dwordx4 v[204:207], v246, s[8:11], s40 offen offset:640
    s_mov_b32 s40, 57344
    buffer_load_dwordx4 v[208:211], v246, s[8:11], s40 offen offset:640
    s_mov_b32 s40, 86016
    buffer_load_dwordx4 v[212:215], v246, s[8:11], s40 offen offset:640
    s_mov_b32 s40, 0
    buffer_load_dwordx4 v[216:219], v246, s[8:11], s40 offen offset:768
    s_mov_b32 s40, 28672
    buffer_load_dwordx4 v[220:223], v246, s[8:11], s40 offen offset:768
    s_mov_b32 s40, 57344
    buffer_load_dwordx4 v[224:227], v246, s[8:11], s40 offen offset:768
    s_mov_b32 s40, 86016
    buffer_load_dwordx4 v[228:231], v246, s[8:11], s40 offen offset:768
    s_mov_b32 s48, s30
    s_mov_b32 s49, s31
    s_mov_b32 s50, 896
    s_mov_b32 s51, 0x00020000
    v_lshrrev_b32 v4, 3, v0
    v_and_b32 v9, 7, v0
    v_cmp_gt_u32 vcc, 4, v9
    v_mov_b32 v16, s26
    v_mov_b32 v17, s27
    v_mov_b32 v18, s24
    v_mov_b32 v19, s25
    v_cndmask_b32 v16, v16, v18, vcc
    v_cndmask_b32 v17, v17, v19, vcc
    v_and_b32 v18, 3, v9
    v_mul_u32_u24 v19, 56, v4
    v_lshl_add_u32 v19, v18, 4, v19
    v_add_co_u32 v16, vcc, v16, v19
    s_nop 1
    v_addc_co_u32 v17, vcc, 0, v17, vcc
    v_cmp_eq_u32 vcc, 3, v18
    v_mov_b32 v20, 8
    s_nop 0
    v_cndmask_b32 v20, v20, 0, vcc
    v_add_co_u32 v22, vcc, v16, v20
    s_nop 1
    v_addc_co_u32 v23, vcc, 0, v17, vcc
    v_lshlrev_b32 v21, 1, v4
    v_mov_b32 v24, 0x7fffffff
    v_cmp_eq_u32 vcc, 7, v9
    s_nop 1
    v_cndmask_b32 v21, v24, v21, vcc
    global_load_dwordx2 v[64:65], v[16:17], off offset:0
    global_load_dwordx2 v[66:67], v[22:23], off offset:0
    s_mov_b32 s42, 0
    buffer_load_ushort v26, v21, s[48:51], s42 offen
    global_load_dwordx2 v[68:69], v[16:17], off offset:1792
    global_load_dwordx2 v[70:71], v[22:23], off offset:1792
    s_mov_b32 s42, 64
    buffer_load_ushort v27, v21, s[48:51], s42 offen
    global_load_dwordx2 v[72:73], v[16:17], off offset:3584
    global_load_dwordx2 v[74:75], v[22:23], off offset:3584
    s_mov_b32 s42, 128
    buffer_load_ushort v28, v21, s[48:51], s42 offen
    v_add_co_u32 v16, vcc, 5376, v16
    s_nop 1
    v_addc_co_u32 v17, vcc, 0, v17, vcc
    v_add_co_u32 v22, vcc, 5376, v22
    s_nop 1
    v_addc_co_u32 v23, vcc, 0, v23, vcc
    global_load_dwordx2 v[76:77], v[16:17], off offset:0
    global_load_dwordx2 v[78:79], v[22:23], off offset:0
    s_mov_b32 s42, 192
    buffer_load_ushort v29, v21, s[48:51], s42 offen
    v_add_co_u32 v16, vcc, 1792, v16
    s_nop 1
    v_addc_co_u32 v17, vcc, 0, v17, vcc
    v_add_co_u32 v22, vcc, 1792, v22
    s_nop 1
    v_addc_co_u32 v23, vcc, 0, v23, vcc
    global_load_dwordx2 v[80:81], v[16:17], off offset:0
    global_load_dwordx2 v[82:83], v[22:23], off offset:0
    s_mov_b32 s42, 256
    buffer_load_ushort v30, v21, s[48:51], s42 offen
    v_add_co_u32 v16, vcc, 1792, v16
    s_nop 1
    v_addc_co_u32 v17, vcc, 0, v17, vcc
    v_add_co_u32 v22, vcc, 1792, v22
    s_nop 1
    v_addc_co_u32 v23, vcc, 0, v23, vcc
    global_load_dwordx2 v[84:85], v[16:17], off offset:0
    global_load_dwordx2 v[86:87], v[22:23], off offset:0
    s_mov_b32 s42, 320
    buffer_load_ushort v31, v21, s[48:51], s42 offen
    v_add_co_u32 v16, vcc, 1792, v16
    s_nop 1
    v_addc_co_u32 v17, vcc, 0, v17, vcc
    v_add_co_u32 v22, vcc, 1792, v22
    s_nop 1
    v_addc_co_u32 v23, vcc, 0, v23, vcc
    global_load_dwordx2 v[88:89], v[16:17], off offset:0
    global_load_dwordx2 v[90:91], v[22:23], off offset:0
    s_mov_b32 s42, 384
    buffer_load_ushort v32, v21, s[48:51], s42 offen
    v_add_co_u32 v16, vcc, 1792, v16
    s_nop 1
    v_addc_co_u32 v17, vcc, 0, v17, vcc
    v_add_co_u32 v22, vcc, 1792, v22
    s_nop 1
    v_addc_co_u32 v23, vcc, 0, v23, vcc
    global_load_dwordx2 v[92:93], v[16:17], off offset:0
    global_load_dwordx2 v[94:95], v[22:23], off offset:0
    s_mov_b32 s42, 448
    buffer_load_ushort v33, v21, s[48:51], s42 offen
    v_add_co_u32 v16, vcc, 1792, v16
    s_nop 1
    v_addc_co_u32 v17, vcc, 0, v17, vcc
    v_add_co_u32 v22, vcc, 1792, v22
    s_nop 1
    v_addc_co_u32 v23, vcc, 0, v23, vcc
    global_load_dwordx2 v[96:97], v[16:17], off offset:0
    global_load_dwordx2 v[98:99], v[22:23], off offset:0
    s_mov_b32 s42, 512
    buffer_load_ushort v34, v21, s[48:51], s42 offen
    v_add_co_u32 v16, vcc, 1792, v16
    s_nop 1
    v_addc_co_u32 v17, vcc, 0, v17, vcc
    v_add_co_u32 v22, vcc, 1792, v22
    s_nop 1
    v_addc_co_u32 v23, vcc, 0, v23, vcc
    global_load_dwordx2 v[100:101], v[16:17], off offset:0
    global_load_dwordx2 v[102:103], v[22:23], off offset:0
    s_mov_b32 s42, 576
    buffer_load_ushort v35, v21, s[48:51], s42 offen
    v_add_co_u32 v16, vcc, 1792, v16
    s_nop 1
    v_addc_co_u32 v17, vcc, 0, v17, vcc
    v_add_co_u32 v22, vcc, 1792, v22
    s_nop 1
    v_addc_co_u32 v23, vcc, 0, v23, vcc
    global_load_dwordx2 v[104:105], v[16:17], off offset:0
    global_load_dwordx2 v[106:107], v[22:23], off offset:0
    s_mov_b32 s42, 640
    buffer_load_ushort v36, v21, s[48:51], s42 offen
    v_add_co_u32 v16, vcc, 1792, v16
    s_nop 1
    v_addc_co_u32 v17, vcc, 0, v17, vcc
    v_add_co_u32 v22, vcc, 1792, v22
    s_nop 1
    v_addc_co_u32 v23, vcc, 0, v23, vcc
    global_load_dwordx2 v[108:109], v[16:17], off offset:0
    global_load_dwordx2 v[110:111], v[22:23], off offset:0
    s_mov_b32 s42, 704
    buffer_load_ushort v37, v21, s[48:51], s42 offen
    v_add_co_u32 v16, vcc, 1792, v16
    s_nop 1
    v_addc_co_u32 v17, vcc, 0, v17, vcc
    v_add_co_u32 v22, vcc, 1792, v22
    s_nop 1
    v_addc_co_u32 v23, vcc, 0, v23, vcc
    global_load_dwordx2 v[112:113], v[16:17], off offset:0
    global_load_dwordx2 v[114:115], v[22:23], off offset:0
    s_mov_b32 s42, 768
    buffer_load_ushort v38, v21, s[48:51], s42 offen
    v_add_co_u32 v16, vcc, 1792, v16
    s_nop 1
    v_addc_co_u32 v17, vcc, 0, v17, vcc
    v_add_co_u32 v22, vcc, 1792, v22
    s_nop 1
    v_addc_co_u32 v23, vcc, 0, v23, vcc
    global_load_dwordx2 v[116:117], v[16:17], off offset:0
    global_load_dwordx2 v[118:119], v[22:23], off offset:0
    s_mov_b32 s42, 832
    buffer_load_ushort v39, v21, s[48:51], s42 offen
    v_add_co_u32 v16, vcc, 1792, v16
    s_nop 1
    v_addc_co_u32 v17, vcc, 0, v17, vcc
    v_add_co_u32 v22, vcc, 1792, v22
    s_nop 1
    v_addc_co_u32 v23, vcc, 0, v23, vcc
    v_cmp_eq_u32 vcc, 3, v18
    s_waitcnt vmcnt(0)
    v_cndmask_b32 v66, v66, v26, vcc
    v_cndmask_b32 v67, v67, 0, vcc
    v_cndmask_b32 v70, v70, v27, vcc
    v_cndmask_b32 v71, v71, 0, vcc
    v_cndmask_b32 v74, v74, v28, vcc
    v_cndmask_b32 v75, v75, 0, vcc
    v_cndmask_b32 v78, v78, v29, vcc
    v_cndmask_b32 v79, v79, 0, vcc
    v_cndmask_b32 v82, v82, v30, vcc
    v_cndmask_b32 v83, v83, 0, vcc
    v_cndmask_b32 v86, v86, v31, vcc
    v_cndmask_b32 v87, v87, 0, vcc
    v_cndmask_b32 v90, v90, v32, vcc
    v_cndmask_b32 v91, v91, 0, vcc
    v_cndmask_b32 v94, v94, v33, vcc
    v_cndmask_b32 v95, v95, 0, vcc
    v_cndmask_b32 v98, v98, v34, vcc
    v_cndmask_b32 v99, v99, 0, vcc
    v_cndmask_b32 v102, v102, v35, vcc
    v_cndmask_b32 v103, v103, 0, vcc
    v_cndmask_b32 v106, v106, v36, vcc
    v_cndmask_b32 v107, v107, 0, vcc
    v_cndmask_b32 v110, v110, v37, vcc
    v_cndmask_b32 v111, v111, 0, vcc
    v_cndmask_b32 v114, v114, v38, vcc
    v_cndmask_b32 v115, v115, 0, vcc
    v_cndmask_b32 v118, v118, v39, vcc
    v_cndmask_b32 v119, v119, 0, vcc
    v_mov_b32 v16, 0
    v_mov_b32 v17, 0
    v_mov_b32 v18, 0
    v_mov_b32 v19, 0
    v_mov_b32 v20, 0
    v_mov_b32 v21, 0
    v_mov_b32 v22, 0
    v_mov_b32 v23, 0
    v_mov_b32 v24, 0
    v_mov_b32 v25, 0
    v_mov_b32 v26, 0
    v_mov_b32 v27, 0
    v_mov_b32 v28, 0
    v_mov_b32 v29, 0
    v_mov_b32 v30, 0
    v_mov_b32 v31, 0
    v_mov_b32 v32, 0
    v_mov_b32 v33, 0
    v_mov_b32 v34, 0
    v_mov_b32 v35, 0
    v_mov_b32 v36, 0
    v_mov_b32 v37, 0
    v_mov_b32 v38, 0
    v_mov_b32 v39, 0
    v_mov_b32 v40, 0
    v_mov_b32 v41, 0
    v_mov_b32 v42, 0
    v_mov_b32 v43, 0
    v_mov_b32 v44, 0
    v_mov_b32 v45, 0
    v_mov_b32 v46, 0
    v_mov_b32 v47, 0
    s_waitcnt vmcnt(0)
    ds_write_b128 v2, v[64:67] offset:16384
    ds_write_b128 v2, v[68:71] offset:20480
    ds_write_b128 v240, v[120:123] offset:0
    ds_write_b128 v240, v[124:127] offset:4096
    ds_write_b128 v240, v[128:131] offset:8192
    ds_write_b128 v240, v[132:135] offset:12288
    s_waitcnt lgkmcnt(0)
    s_barrier
    ds_read_b64_tr_b16 v[48:49], v3 offset:16384
    ds_read_b64_tr_b16 v[50:51], v3 offset:16896
    ds_read_b64_tr_b16 v[52:53], v11 offset:16384
    ds_read_b64_tr_b16 v[54:55], v11 offset:16896
    ds_read_b128 v[232:235], v241 offset:0
    s_waitcnt vmcnt(0)
    ds_write_b128 v2, v[72:75] offset:40960
    ds_write_b128 v2, v[76:79] offset:45056
    ds_write_b128 v240, v[136:139] offset:24576
    ds_write_b128 v240, v[140:143] offset:28672
    ds_write_b128 v240, v[144:147] offset:32768
    ds_write_b128 v240, v[148:151] offset:36864
    ds_read_b64_tr_b16 v[56:57], v3 offset:18432
    ds_read_b64_tr_b16 v[58:59], v3 offset:18944
    ds_read_b64_tr_b16 v[60:61], v11 offset:18432
    ds_read_b64_tr_b16 v[62:63], v11 offset:18944
    ds_read_b128 v[236:239], v242 offset:0
    s_waitcnt lgkmcnt(5)
    v_mfma_f32_32x32x16_bf16 v[16:31], v[48:51], v[232:235], v[16:31]
    v_mfma_f32_32x32x16_bf16 v[32:47], v[52:55], v[232:235], v[32:47]
    ds_read_b64_tr_b16 v[48:49], v3 offset:20480
    ds_read_b64_tr_b16 v[50:51], v3 offset:20992
    ds_read_b64_tr_b16 v[52:53], v11 offset:20480
    ds_read_b64_tr_b16 v[54:55], v11 offset:20992
    ds_read_b128 v[232:235], v243 offset:0
    s_waitcnt lgkmcnt(5)
    v_mfma_f32_32x32x16_bf16 v[16:31], v[56:59], v[236:239], v[16:31]
    v_mfma_f32_32x32x16_bf16 v[32:47], v[60:63], v[236:239], v[32:47]
    ds_read_b64_tr_b16 v[56:57], v3 offset:22528
    ds_read_b64_tr_b16 v[58:59], v3 offset:23040
    ds_read_b64_tr_b16 v[60:61], v11 offset:22528
    ds_read_b64_tr_b16 v[62:63], v11 offset:23040
    ds_read_b128 v[236:239], v244 offset:0
    s_waitcnt lgkmcnt(5)
    v_mfma_f32_32x32x16_bf16 v[16:31], v[48:51], v[232:235], v[16:31]
    v_mfma_f32_32x32x16_bf16 v[32:47], v[52:55], v[232:235], v[32:47]
    s_waitcnt lgkmcnt(0)
    v_mfma_f32_32x32x16_bf16 v[16:31], v[56:59], v[236:239], v[16:31]
    v_mfma_f32_32x32x16_bf16 v[32:47], v[60:63], v[236:239], v[32:47]
    s_barrier
    ds_read_b64_tr_b16 v[48:49], v3 offset:40960
    ds_read_b64_tr_b16 v[50:51], v3 offset:41472
    ds_read_b64_tr_b16 v[52:53], v11 offset:40960
    ds_read_b64_tr_b16 v[54:55], v11 offset:41472
    ds_read_b128 v[232:235], v241 offset:24576
    s_waitcnt vmcnt(0)
    ds_write_b128 v2, v[80:83] offset:16384
    ds_write_b128 v2, v[84:87] offset:20480
    ds_write_b128 v240, v[152:155] offset:0
    ds_write_b128 v240, v[156:159] offset:4096
    ds_write_b128 v240, v[160:163] offset:8192
    ds_write_b128 v240, v[164:167] offset:12288
    ds_read_b64_tr_b16 v[56:57], v3 offset:43008
    ds_read_b64_tr_b16 v[58:59], v3 offset:43520
    ds_read_b64_tr_b16 v[60:61], v11 offset:43008
    ds_read_b64_tr_b16 v[62:63], v11 offset:43520
    ds_read_b128 v[236:239], v242 offset:24576
    s_waitcnt lgkmcnt(5)
    v_mfma_f32_32x32x16_bf16 v[16:31], v[48:51], v[232:235], v[16:31]
    v_mfma_f32_32x32x16_bf16 v[32:47], v[52:55], v[232:235], v[32:47]
    ds_read_b64_tr_b16 v[48:49], v3 offset:45056
    ds_read_b64_tr_b16 v[50:51], v3 offset:45568
    ds_read_b64_tr_b16 v[52:53], v11 offset:45056
    ds_read_b64_tr_b16 v[54:55], v11 offset:45568
    ds_read_b128 v[232:235], v243 offset:24576
    s_waitcnt lgkmcnt(5)
    v_mfma_f32_32x32x16_bf16 v[16:31], v[56:59], v[236:239], v[16:31]
    v_mfma_f32_32x32x16_bf16 v[32:47], v[60:63], v[236:239], v[32:47]
    ds_read_b64_tr_b16 v[56:57], v3 offset:47104
    ds_read_b64_tr_b16 v[58:59], v3 offset:47616
    ds_read_b64_tr_b16 v[60:61], v11 offset:47104
    ds_read_b64_tr_b16 v[62:63], v11 offset:47616
    ds_read_b128 v[236:239], v244 offset:24576
    s_waitcnt lgkmcnt(5)
    v_mfma_f32_32x32x16_bf16 v[16:31], v[48:51], v[232:235], v[16:31]
    v_mfma_f32_32x32x16_bf16 v[32:47], v[52:55], v[232:235], v[32:47]
    s_waitcnt lgkmcnt(0)
    v_mfma_f32_32x32x16_bf16 v[16:31], v[56:59], v[236:239], v[16:31]
    v_mfma_f32_32x32x16_bf16 v[32:47], v[60:63], v[236:239], v[32:47]
    s_barrier
    ds_read_b64_tr_b16 v[48:49], v3 offset:16384
    ds_read_b64_tr_b16 v[50:51], v3 offset:16896
    ds_read_b64_tr_b16 v[52:53], v11 offset:16384
    ds_read_b64_tr_b16 v[54:55], v11 offset:16896
    ds_read_b128 v[232:235], v241 offset:0
    s_waitcnt vmcnt(0)
    ds_write_b128 v2, v[88:91] offset:40960
    ds_write_b128 v2, v[92:95] offset:45056
    ds_write_b128 v240, v[168:171] offset:24576
    ds_write_b128 v240, v[172:175] offset:28672
    ds_write_b128 v240, v[176:179] offset:32768
    ds_write_b128 v240, v[180:183] offset:36864
    ds_read_b64_tr_b16 v[56:57], v3 offset:18432
    ds_read_b64_tr_b16 v[58:59], v3 offset:18944
    ds_read_b64_tr_b16 v[60:61], v11 offset:18432
    ds_read_b64_tr_b16 v[62:63], v11 offset:18944
    ds_read_b128 v[236:239], v242 offset:0
    s_waitcnt lgkmcnt(5)
    v_mfma_f32_32x32x16_bf16 v[16:31], v[48:51], v[232:235], v[16:31]
    v_mfma_f32_32x32x16_bf16 v[32:47], v[52:55], v[232:235], v[32:47]
    ds_read_b64_tr_b16 v[48:49], v3 offset:20480
    ds_read_b64_tr_b16 v[50:51], v3 offset:20992
    ds_read_b64_tr_b16 v[52:53], v11 offset:20480
    ds_read_b64_tr_b16 v[54:55], v11 offset:20992
    ds_read_b128 v[232:235], v243 offset:0
    s_waitcnt lgkmcnt(5)
    v_mfma_f32_32x32x16_bf16 v[16:31], v[56:59], v[236:239], v[16:31]
    v_mfma_f32_32x32x16_bf16 v[32:47], v[60:63], v[236:239], v[32:47]
    ds_read_b64_tr_b16 v[56:57], v3 offset:22528
    ds_read_b64_tr_b16 v[58:59], v3 offset:23040
    ds_read_b64_tr_b16 v[60:61], v11 offset:22528
    ds_read_b64_tr_b16 v[62:63], v11 offset:23040
    ds_read_b128 v[236:239], v244 offset:0
    s_waitcnt lgkmcnt(5)
    v_mfma_f32_32x32x16_bf16 v[16:31], v[48:51], v[232:235], v[16:31]
    v_mfma_f32_32x32x16_bf16 v[32:47], v[52:55], v[232:235], v[32:47]
    s_waitcnt lgkmcnt(0)
    v_mfma_f32_32x32x16_bf16 v[16:31], v[56:59], v[236:239], v[16:31]
    v_mfma_f32_32x32x16_bf16 v[32:47], v[60:63], v[236:239], v[32:47]
    s_barrier
    ds_read_b64_tr_b16 v[48:49], v3 offset:40960
    ds_read_b64_tr_b16 v[50:51], v3 offset:41472
    ds_read_b64_tr_b16 v[52:53], v11 offset:40960
    ds_read_b64_tr_b16 v[54:55], v11 offset:41472
    ds_read_b128 v[232:235], v241 offset:24576
    s_waitcnt vmcnt(0)
    ds_write_b128 v2, v[96:99] offset:16384
    ds_write_b128 v2, v[100:103] offset:20480
    ds_write_b128 v240, v[184:187] offset:0
    ds_write_b128 v240, v[188:191] offset:4096
    ds_write_b128 v240, v[192:195] offset:8192
    ds_write_b128 v240, v[196:199] offset:12288
    ds_read_b64_tr_b16 v[56:57], v3 offset:43008
    ds_read_b64_tr_b16 v[58:59], v3 offset:43520
    ds_read_b64_tr_b16 v[60:61], v11 offset:43008
    ds_read_b64_tr_b16 v[62:63], v11 offset:43520
    ds_read_b128 v[236:239], v242 offset:24576
    s_waitcnt lgkmcnt(5)
    v_mfma_f32_32x32x16_bf16 v[16:31], v[48:51], v[232:235], v[16:31]
    v_mfma_f32_32x32x16_bf16 v[32:47], v[52:55], v[232:235], v[32:47]
    ds_read_b64_tr_b16 v[48:49], v3 offset:45056
    ds_read_b64_tr_b16 v[50:51], v3 offset:45568
    ds_read_b64_tr_b16 v[52:53], v11 offset:45056
    ds_read_b64_tr_b16 v[54:55], v11 offset:45568
    ds_read_b128 v[232:235], v243 offset:24576
    s_waitcnt lgkmcnt(5)
    v_mfma_f32_32x32x16_bf16 v[16:31], v[56:59], v[236:239], v[16:31]
    v_mfma_f32_32x32x16_bf16 v[32:47], v[60:63], v[236:239], v[32:47]
    ds_read_b64_tr_b16 v[56:57], v3 offset:47104
    ds_read_b64_tr_b16 v[58:59], v3 offset:47616
    ds_read_b64_tr_b16 v[60:61], v11 offset:47104
    ds_read_b64_tr_b16 v[62:63], v11 offset:47616
    ds_read_b128 v[236:239], v244 offset:24576
    s_waitcnt lgkmcnt(5)
    v_mfma_f32_32x32x16_bf16 v[16:31], v[48:51], v[232:235], v[16:31]
    v_mfma_f32_32x32x16_bf16 v[32:47], v[52:55], v[232:235], v[32:47]
    s_waitcnt lgkmcnt(0)
    v_mfma_f32_32x32x16_bf16 v[16:31], v[56:59], v[236:239], v[16:31]
    v_mfma_f32_32x32x16_bf16 v[32:47], v[60:63], v[236:239], v[32:47]
    s_barrier
    ds_read_b64_tr_b16 v[48:49], v3 offset:16384
    ds_read_b64_tr_b16 v[50:51], v3 offset:16896
    ds_read_b64_tr_b16 v[52:53], v11 offset:16384
    ds_read_b64_tr_b16 v[54:55], v11 offset:16896
    ds_read_b128 v[232:235], v241 offset:0
    s_waitcnt vmcnt(0)
    ds_write_b128 v2, v[104:107] offset:40960
    ds_write_b128 v2, v[108:111] offset:45056
    ds_write_b128 v240, v[200:203] offset:24576
    ds_write_b128 v240, v[204:207] offset:28672
    ds_write_b128 v240, v[208:211] offset:32768
    ds_write_b128 v240, v[212:215] offset:36864
    ds_read_b64_tr_b16 v[56:57], v3 offset:18432
    ds_read_b64_tr_b16 v[58:59], v3 offset:18944
    ds_read_b64_tr_b16 v[60:61], v11 offset:18432
    ds_read_b64_tr_b16 v[62:63], v11 offset:18944
    ds_read_b128 v[236:239], v242 offset:0
    s_waitcnt lgkmcnt(5)
    v_mfma_f32_32x32x16_bf16 v[16:31], v[48:51], v[232:235], v[16:31]
    v_mfma_f32_32x32x16_bf16 v[32:47], v[52:55], v[232:235], v[32:47]
    ds_read_b64_tr_b16 v[48:49], v3 offset:20480
    ds_read_b64_tr_b16 v[50:51], v3 offset:20992
    ds_read_b64_tr_b16 v[52:53], v11 offset:20480
    ds_read_b64_tr_b16 v[54:55], v11 offset:20992
    ds_read_b128 v[232:235], v243 offset:0
    s_waitcnt lgkmcnt(5)
    v_mfma_f32_32x32x16_bf16 v[16:31], v[56:59], v[236:239], v[16:31]
    v_mfma_f32_32x32x16_bf16 v[32:47], v[60:63], v[236:239], v[32:47]
    ds_read_b64_tr_b16 v[56:57], v3 offset:22528
    ds_read_b64_tr_b16 v[58:59], v3 offset:23040
    ds_read_b64_tr_b16 v[60:61], v11 offset:22528
    ds_read_b64_tr_b16 v[62:63], v11 offset:23040
    ds_read_b128 v[236:239], v244 offset:0
    s_waitcnt lgkmcnt(5)
    v_mfma_f32_32x32x16_bf16 v[16:31], v[48:51], v[232:235], v[16:31]
    v_mfma_f32_32x32x16_bf16 v[32:47], v[52:55], v[232:235], v[32:47]
    s_waitcnt lgkmcnt(0)
    v_mfma_f32_32x32x16_bf16 v[16:31], v[56:59], v[236:239], v[16:31]
    v_mfma_f32_32x32x16_bf16 v[32:47], v[60:63], v[236:239], v[32:47]
    s_barrier
    ds_read_b64_tr_b16 v[48:49], v3 offset:40960
    ds_read_b64_tr_b16 v[50:51], v3 offset:41472
    ds_read_b64_tr_b16 v[52:53], v11 offset:40960
    ds_read_b64_tr_b16 v[54:55], v11 offset:41472
    ds_read_b128 v[232:235], v241 offset:24576
    s_waitcnt vmcnt(0)
    ds_write_b128 v2, v[112:115] offset:16384
    ds_write_b128 v2, v[116:119] offset:20480
    ds_write_b128 v240, v[216:219] offset:0
    ds_write_b128 v240, v[220:223] offset:4096
    ds_write_b128 v240, v[224:227] offset:8192
    ds_write_b128 v240, v[228:231] offset:12288
    ds_read_b64_tr_b16 v[56:57], v3 offset:43008
    ds_read_b64_tr_b16 v[58:59], v3 offset:43520
    ds_read_b64_tr_b16 v[60:61], v11 offset:43008
    ds_read_b64_tr_b16 v[62:63], v11 offset:43520
    ds_read_b128 v[236:239], v242 offset:24576
    s_waitcnt lgkmcnt(5)
    v_mfma_f32_32x32x16_bf16 v[16:31], v[48:51], v[232:235], v[16:31]
    v_mfma_f32_32x32x16_bf16 v[32:47], v[52:55], v[232:235], v[32:47]
    ds_read_b64_tr_b16 v[48:49], v3 offset:45056
    ds_read_b64_tr_b16 v[50:51], v3 offset:45568
    ds_read_b64_tr_b16 v[52:53], v11 offset:45056
    ds_read_b64_tr_b16 v[54:55], v11 offset:45568
    ds_read_b128 v[232:235], v243 offset:24576
    s_waitcnt lgkmcnt(5)
    v_mfma_f32_32x32x16_bf16 v[16:31], v[56:59], v[236:239], v[16:31]
    v_mfma_f32_32x32x16_bf16 v[32:47], v[60:63], v[236:239], v[32:47]
    ds_read_b64_tr_b16 v[56:57], v3 offset:47104
    ds_read_b64_tr_b16 v[58:59], v3 offset:47616
    ds_read_b64_tr_b16 v[60:61], v11 offset:47104
    ds_read_b64_tr_b16 v[62:63], v11 offset:47616
    ds_read_b128 v[236:239], v244 offset:24576
    s_waitcnt lgkmcnt(5)
    v_mfma_f32_32x32x16_bf16 v[16:31], v[48:51], v[232:235], v[16:31]
    v_mfma_f32_32x32x16_bf16 v[32:47], v[52:55], v[232:235], v[32:47]
    s_waitcnt lgkmcnt(0)
    v_mfma_f32_32x32x16_bf16 v[16:31], v[56:59], v[236:239], v[16:31]
    v_mfma_f32_32x32x16_bf16 v[32:47], v[60:63], v[236:239], v[32:47]
    s_barrier
    ds_read_b64_tr_b16 v[48:49], v3 offset:16384
    ds_read_b64_tr_b16 v[50:51], v3 offset:16896
    ds_read_b64_tr_b16 v[52:53], v11 offset:16384
    ds_read_b64_tr_b16 v[54:55], v11 offset:16896
    ds_read_b128 v[232:235], v241 offset:0
    ds_read_b64_tr_b16 v[56:57], v3 offset:18432
    ds_read_b64_tr_b16 v[58:59], v3 offset:18944
    ds_read_b64_tr_b16 v[60:61], v11 offset:18432
    ds_read_b64_tr_b16 v[62:63], v11 offset:18944
    ds_read_b128 v[236:239], v242 offset:0
    s_waitcnt lgkmcnt(5)
    v_mfma_f32_32x32x16_bf16 v[16:31], v[48:51], v[232:235], v[16:31]
    v_mfma_f32_32x32x16_bf16 v[32:47], v[52:55], v[232:235], v[32:47]
    ds_read_b64_tr_b16 v[48:49], v3 offset:20480
    ds_read_b64_tr_b16 v[50:51], v3 offset:20992
    ds_read_b64_tr_b16 v[52:53], v11 offset:20480
    ds_read_b64_tr_b16 v[54:55], v11 offset:20992
    ds_read_b128 v[232:235], v243 offset:0
    s_waitcnt lgkmcnt(5)
    v_mfma_f32_32x32x16_bf16 v[16:31], v[56:59], v[236:239], v[16:31]
    v_mfma_f32_32x32x16_bf16 v[32:47], v[60:63], v[236:239], v[32:47]
    ds_read_b64_tr_b16 v[56:57], v3 offset:22528
    ds_read_b64_tr_b16 v[58:59], v3 offset:23040
    ds_read_b64_tr_b16 v[60:61], v11 offset:22528
    ds_read_b64_tr_b16 v[62:63], v11 offset:23040
    ds_read_b128 v[236:239], v244 offset:0
    s_waitcnt lgkmcnt(5)
    v_mfma_f32_32x32x16_bf16 v[16:31], v[48:51], v[232:235], v[16:31]
    v_mfma_f32_32x32x16_bf16 v[32:47], v[52:55], v[232:235], v[32:47]
    s_waitcnt lgkmcnt(0)
    v_mfma_f32_32x32x16_bf16 v[16:31], v[56:59], v[236:239], v[16:31]
    v_mfma_f32_32x32x16_bf16 v[32:47], v[60:63], v[236:239], v[32:47]
    s_nop 15
    s_nop 3
    s_add_u32 s16, s32, 2097152
    s_addc_u32 s17, s33, 0
    s_mov_b32 s18, 131072
    s_mov_b32 s19, 0x00020000
    s_add_u32 s44, s32, 2228224
    s_addc_u32 s45, s33, 0
    s_mov_b32 s46, 131072
    s_mov_b32 s47, 0x00020000
    s_add_u32 s48, s32, 2359296
    s_addc_u32 s49, s33, 0
    s_mov_b32 s50, 8192
    s_mov_b32 s51, 0x00020000
    v_lshrrev_b32 v4, 5, v7
    v_lshlrev_b32 v9, 11, v4
    v_and_b32 v4, 31, v7
    v_lshl_add_u32 v9, v4, 4, v9
    v_lshrrev_b32 v4, 5, v7
    v_lshlrev_b32 v10, 11, v4
    v_bfe_u32 v4, v7, 4, 1
    v_lshl_add_u32 v10, v4, 10, v10
    v_bfe_u32 v4, v7, 2, 1
    v_lshl_add_u32 v10, v4, 9, v10
    v_bfe_u32 v4, v7, 3, 1
    v_lshl_add_u32 v10, v4, 3, v10
    v_and_b32 v4, 3, v7
    v_lshl_add_u32 v10, v4, 1, v10
    v_mov_b32 v14, 0
    v_mov_b32 v15, 0
    v_mov_b32 v11, 0x3f80
    s_mov_b32 exec_lo, -1
    s_mov_b32 exec_hi, 0
    v_cvt_pk_bf16_f32 v12, v16, v17
    v_cvt_pk_bf16_f32 v13, v18, v19
    buffer_store_dwordx2 v[12:13], v9, s[16:19], 0 offen offset:0
    s_nop 0
    s_mov_b32 exec_lo, 0
    s_mov_b32 exec_hi, -1
    v_cvt_pk_bf16_f32 v12, v16, v17
    v_cvt_pk_bf16_f32 v13, v18, v19
    buffer_store_dwordx2 v[12:13], v9, s[16:19], 0 offen offset:8
    s_nop 0
    s_mov_b32 exec_lo, -1
    s_mov_b32 exec_hi, 0
    v_cvt_pk_bf16_f32 v12, v20, v21
    v_cvt_pk_bf16_f32 v13, v22, v23
    buffer_store_dwordx2 v[12:13], v9, s[16:19], 0 offen offset:512
    s_nop 0
    s_mov_b32 exec_lo, 0
    s_mov_b32 exec_hi, -1
    v_cvt_pk_bf16_f32 v12, v20, v21
    v_cvt_pk_bf16_f32 v13, v22, v23
    buffer_store_dwordx2 v[12:13], v9, s[16:19], 0 offen offset:520
    s_nop 0
    s_mov_b32 exec_lo, -1
    s_mov_b32 exec_hi, 0
    v_cvt_pk_bf16_f32 v12, v24, v25
    v_cvt_pk_bf16_f32 v13, v26, v27
    buffer_store_dwordx2 v[12:13], v9, s[16:19], 0 offen offset:1024
    s_nop 0
    s_mov_b32 exec_lo, 0
    s_mov_b32 exec_hi, -1
    v_cvt_pk_bf16_f32 v12, v24, v25
    v_cvt_pk_bf16_f32 v13, v26, v27
    buffer_store_dwordx2 v[12:13], v9, s[16:19], 0 offen offset:1032
    s_nop 0
    s_mov_b32 exec_lo, -1
    s_mov_b32 exec_hi, 0
    v_cvt_pk_bf16_f32 v12, v28, v29
    v_cvt_pk_bf16_f32 v13, v30, v31
    buffer_store_dwordx2 v[12:13], v9, s[16:19], 0 offen offset:1536
    v_mov_b32 v14, 0x3f80
    buffer_store_dwordx2 v[14:15], v9, s[16:19], 0 offen offset:1544
    s_nop 1
    v_mov_b32 v14, 0
    s_nop 0
    s_mov_b32 exec_lo, -1
    s_mov_b32 exec_hi, 0
    v_cvt_pk_bf16_f32 v12, v32, v33
    v_cvt_pk_bf16_f32 v13, v34, v35
    buffer_store_short v12, v10, s[44:47], 0 offen offset:0
    buffer_store_short_d16_hi v12, v10, s[44:47], 0 offen offset:16
    buffer_store_short v13, v10, s[44:47], 0 offen offset:32
    buffer_store_short_d16_hi v13, v10, s[44:47], 0 offen offset:48
    s_nop 0
    s_mov_b32 exec_lo, 0
    s_mov_b32 exec_hi, -1
    v_cvt_pk_bf16_f32 v12, v32, v33
    v_cvt_pk_bf16_f32 v13, v34, v35
    buffer_store_short v12, v10, s[44:47], 0 offen offset:64
    buffer_store_short_d16_hi v12, v10, s[44:47], 0 offen offset:80
    buffer_store_short v13, v10, s[44:47], 0 offen offset:96
    buffer_store_short_d16_hi v13, v10, s[44:47], 0 offen offset:112
    s_nop 0
    s_mov_b32 exec_lo, -1
    s_mov_b32 exec_hi, 0
    v_cvt_pk_bf16_f32 v12, v36, v37
    v_cvt_pk_bf16_f32 v13, v38, v39
    buffer_store_short v12, v10, s[44:47], 0 offen offset:128
    buffer_store_short_d16_hi v12, v10, s[44:47], 0 offen offset:144
    buffer_store_short v13, v10, s[44:47], 0 offen offset:160
    buffer_store_short_d16_hi v13, v10, s[44:47], 0 offen offset:176
    s_nop 0
    s_mov_b32 exec_lo, 0
    s_mov_b32 exec_hi, -1
    v_cvt_pk_bf16_f32 v12, v36, v37
    v_cvt_pk_bf16_f32 v13, v38, v39
    buffer_store_short v12, v10, s[44:47], 0 offen offset:192
    buffer_store_short_d16_hi v12, v10, s[44:47], 0 offen offset:208
    buffer_store_short v13, v10, s[44:47], 0 offen offset:224
    buffer_store_short_d16_hi v13, v10, s[44:47], 0 offen offset:240
    s_nop 0
    s_mov_b32 exec_lo, -1
    s_mov_b32 exec_hi, 0
    v_cvt_pk_bf16_f32 v12, v40, v41
    v_cvt_pk_bf16_f32 v13, v42, v43
    buffer_store_short v12, v10, s[44:47], 0 offen offset:256
    buffer_store_short_d16_hi v12, v10, s[44:47], 0 offen offset:272
    buffer_store_short v13, v10, s[44:47], 0 offen offset:288
    buffer_store_short_d16_hi v13, v10, s[44:47], 0 offen offset:304
    s_nop 0
    s_mov_b32 exec_lo, 0
    s_mov_b32 exec_hi, -1
    v_cvt_pk_bf16_f32 v12, v40, v41
    v_cvt_pk_bf16_f32 v13, v42, v43
    buffer_store_short v12, v10, s[44:47], 0 offen offset:320
    buffer_store_short_d16_hi v12, v10, s[44:47], 0 offen offset:336
    buffer_store_short v13, v10, s[44:47], 0 offen offset:352
    buffer_store_short_d16_hi v13, v10, s[44:47], 0 offen offset:368
    s_nop 0
    s_mov_b32 exec_lo, -1
    s_mov_b32 exec_hi, 0
    v_cvt_pk_bf16_f32 v12, v44, v45
    v_cvt_pk_bf16_f32 v13, v46, v47
    buffer_store_short v12, v10, s[44:47], 0 offen offset:384
    buffer_store_short_d16_hi v12, v10, s[44:47], 0 offen offset:400
    buffer_store_short v13, v10, s[44:47], 0 offen offset:416
    buffer_store_short_d16_hi v13, v10, s[44:47], 0 offen offset:432
    buffer_store_short v11, v10, s[44:47], 0 offen offset:448
    buffer_store_short v14, v10, s[44:47], 0 offen offset:464
    buffer_store_short v14, v10, s[44:47], 0 offen offset:480
    buffer_store_short v14, v10, s[44:47], 0 offen offset:496
    s_nop 0
    s_mov_b32 exec_lo, 0
    s_mov_b32 exec_hi, -1
    v_lshlrev_b32 v12, 2, v7
    buffer_store_dword v44, v12, s[48:51], 0 offen
    s_mov_b64 exec, -1
k1end_1:
    s_endpgm
.section .rodata,"a"
.p2align 6
.amdhsa_kernel k1_proj_kernel
  .amdhsa_next_free_vgpr 248
  .amdhsa_next_free_sgpr 102
  .amdhsa_accum_offset 248
  .amdhsa_group_segment_fixed_size 0
  .amdhsa_kernarg_size 96
  .amdhsa_user_sgpr_count 2
  .amdhsa_user_sgpr_kernarg_segment_ptr 1
  .amdhsa_system_sgpr_workgroup_id_x 1
.end_amdhsa_kernel
.text
.p2align 8
.globl k2_attn_kernel
.type k2_attn_kernel,@function
k2_attn_kernel:
    s_cmp_ge_u32 s2, 256
    s_cbranch_scc1 k2end_12
    s_load_dwordx2 s[20:21], s[0:1], 88
    s_lshr_b32 s4, s2, 4
    s_and_b32 s5, s2, 15
    v_and_b32 v1, 63, v0
    v_lshrrev_b32 v2, 6, v0
    s_nop 0
    v_readfirstlane_b32 s6, v2
    s_and_b32 s7, s6, 3
    s_lshr_b32 s34, s6, 2
    v_bfe_u32 v8, v0, 5, 1
    s_lshl_b32 s35, s5, 7
    s_lshl_b32 s36, s7, 5
    s_add_u32 s35, s35, s36
    v_and_b32 v2, 31, v0
    v_add_u32 v7, s35, v2
    s_waitcnt lgkmcnt(0)
    s_mov_b32 s8, s20
    s_mov_b32 s9, s21
    s_mov_b32 s10, 2097152
    s_mov_b32 s11, 0x00020000
    s_add_u32 s12, s20, 2097152
    s_addc_u32 s13, s21, 0
    s_mov_b32 s14, 262144
    s_mov_b32 s15, 0x00020000
    s_lshl_b32 s36, s4, 17
    v_lshlrev_b32 v2, 6, v7
    v_lshl_add_u32 v2, v8, 4, v2
    v_add_u32 v2, s36, v2
    buffer_load_dwordx4 v[16:19], v2, s[8:11], 0 offen
    buffer_load_dwordx4 v[20:23], v2, s[8:11], 0 offen offset:32
    v_lshrrev_b32 v2, 8, v0
    v_lshlrev_b32 v4, 16, v2
    v_and_b32 v3, 255, v0
    v_lshl_add_u32 v4, v3, 4, v4
    v_lshlrev_b32 v5, 12, v2
    v_lshl_add_u32 v5, v3, 4, v5
    v_lshlrev_b32 v6, 4, v1
    s_lshl_b32 s36, s34, 12
    v_add_u32 v6, s36, v6
    v_mov_b32 v64, 0
    v_mov_b32 v65, 0
    v_mov_b32 v66, 0
    v_mov_b32 v67, 0
    v_mov_b32 v68, 0
    v_mov_b32 v69, 0
    v_mov_b32 v70, 0
    v_mov_b32 v71, 0
    v_mov_b32 v72, 0
    v_mov_b32 v73, 0
    v_mov_b32 v74, 0
    v_mov_b32 v75, 0
    v_mov_b32 v76, 0
    v_mov_b32 v77, 0
    v_mov_b32 v78, 0
    v_mov_b32 v79, 0
    v_mov_b32 v9, 0
    s_cmp_lt_u32 s6, 4
    s_cbranch_scc1 k2nob_13
    s_add_u32 s84, s20, 3145728
    s_addc_u32 s85, s21, 0
    s_mov_b32 s86, 5505024
    s_mov_b32 s87, 0x00020000
    v_lshrrev_b32 v2, 1, v1
    v_add_u32 v10, s35, v2
    v_and_b32 v3, 1, v1
    s_movk_i32 s36, 2688
    v_mul_lo_u32 v11, v10, s36
    v_mul_u32_u24 v2, 28, v3
    v_add_u32 v11, v11, v2
    s_mul_i32 s36, s4, 56
    v_add_u32 v11, s36, v11
    buffer_load_dwordx4 v[24:27], v11, s[84:87], 0 offen
    buffer_load_dwordx3 v[28:30], v11, s[84:87], 0 offen offset:16
    v_and_b32 v3, 255, v0
    s_lshl_b32 s36, s5, 7
    s_sub_u32 s36, s36, 14
    s_mul_i32 s43, s4, 56
    s_add_u32 s43, s43, 896
    v_add_u32 v2, 0, v3
    v_mul_u32_u24 v10, 2341, v2
    v_lshrrev_b32 v10, 16, v10
    v_mul_u32_u24 v11, 28, v10
    v_sub_u32 v11, v2, v11
    v_lshlrev_b32 v144, 2, v2
    v_add_u32 v10, s36, v10
    v_cmp_gt_u32 vcc, 14, v11
    v_lshlrev_b32 v11, 2, v11
    v_add_u32 v12, 840, v11
    v_cndmask_b32 v11, v12, v11, vcc
    s_movk_i32 s44, 2688
    v_mul_lo_u32 v12, v10, s44
    v_add3_u32 v11, v11, v12, s43
    v_cmp_gt_u32 vcc, 2048, v10
    v_mov_b32 v12, 0x7ffffff0
    s_nop 1
    v_cndmask_b32 v11, v12, v11, vcc
    buffer_load_dword v160, v11, s[84:87], 0 offen
    v_add_u32 v2, 256, v3
    v_mul_u32_u24 v10, 2341, v2
    v_lshrrev_b32 v10, 16, v10
    v_mul_u32_u24 v11, 28, v10
    v_sub_u32 v11, v2, v11
    v_lshlrev_b32 v145, 2, v2
    v_add_u32 v10, s36, v10
    v_cmp_gt_u32 vcc, 14, v11
    v_lshlrev_b32 v11, 2, v11
    v_add_u32 v12, 840, v11
    v_cndmask_b32 v11, v12, v11, vcc
    s_movk_i32 s44, 2688
    v_mul_lo_u32 v12, v10, s44
    v_add3_u32 v11, v11, v12, s43
    v_cmp_gt_u32 vcc, 2048, v10
    v_mov_b32 v12, 0x7ffffff0
    s_nop 1
    v_cndmask_b32 v11, v12, v11, vcc
    buffer_load_dword v161, v11, s[84:87], 0 offen
    v_add_u32 v2, 512, v3
    v_mul_u32_u24 v10, 2341, v2
    v_lshrrev_b32 v10, 16, v10
    v_mul_u32_u24 v11, 28, v10
    v_sub_u32 v11, v2, v11
    v_lshlrev_b32 v146, 2, v2
    v_add_u32 v10, s36, v10
    v_cmp_gt_u32 vcc, 14, v11
    v_lshlrev_b32 v11, 2, v11
    v_add_u32 v12, 840, v11
    v_cndmask_b32 v11, v12, v11, vcc
    s_movk_i32 s44, 2688
    v_mul_lo_u32 v12, v10, s44
    v_add3_u32 v11, v11, v12, s43
    v_cmp_gt_u32 vcc, 2048, v10
    v_mov_b32 v12, 0x7ffffff0
    s_nop 1
    v_cndmask_b32 v11, v12, v11, vcc
    buffer_load_dword v162, v11, s[84:87], 0 offen
    v_add_u32 v2, 768, v3
    v_mul_u32_u24 v10, 2341, v2
    v_lshrrev_b32 v10, 16, v10
    v_mul_u32_u24 v11, 28, v10
    v_sub_u32 v11, v2, v11
    v_lshlrev_b32 v147, 2, v2
    v_add_u32 v10, s36, v10
    v_cmp_gt_u32 vcc, 14, v11
    v_lshlrev_b32 v11, 2, v11
    v_add_u32 v12, 840, v11
    v_cndmask_b32 v11, v12, v11, vcc
    s_movk_i32 s44, 2688
    v_mul_lo_u32 v12, v10, s44
    v_add3_u32 v11, v11, v12, s43
    v_cmp_gt_u32 vcc, 2048, v10
    v_mov_b32 v12, 0x7ffffff0
    s_nop 1
    v_cndmask_b32 v11, v12, v11, vcc
    buffer_load_dword v163, v11, s[84:87], 0 offen
    v_add_u32 v2, 1024, v3
    v_mul_u32_u24 v10, 2341, v2
    v_lshrrev_b32 v10, 16, v10
    v_mul_u32_u24 v11, 28, v10
    v_sub_u32 v11, v2, v11
    v_lshlrev_b32 v148, 2, v2
    v_add_u32 v10, s36, v10
    v_cmp_gt_u32 vcc, 14, v11
    v_lshlrev_b32 v11, 2, v11
    v_add_u32 v12, 840, v11
    v_cndmask_b32 v11, v12, v11, vcc
    s_movk_i32 s44, 2688
    v_mul_lo_u32 v12, v10, s44
    v_add3_u32 v11, v11, v12, s43
    v_cmp_gt_u32 vcc, 2048, v10
    v_mov_b32 v12, 0x7ffffff0
    s_nop 1
    v_cndmask_b32 v11, v12, v11, vcc
    buffer_load_dword v164, v11, s[84:87], 0 offen
    v_add_u32 v2, 1280, v3
    v_mul_u32_u24 v10, 2341, v2
    v_lshrrev_b32 v10, 16, v10
    v_mul_u32_u24 v11, 28, v10
    v_sub_u32 v11, v2, v11
    v_lshlrev_b32 v149, 2, v2
    v_add_u32 v10, s36, v10
    v_cmp_gt_u32 vcc, 14, v11
    v_lshlrev_b32 v11, 2, v11
    v_add_u32 v12, 840, v11
    v_cndmask_b32 v11, v12, v11, vcc
    s_movk_i32 s44, 2688
    v_mul_lo_u32 v12, v10, s44
    v_add3_u32 v11, v11, v12, s43
    v_cmp_gt_u32 vcc, 2048, v10
    v_mov_b32 v12, 0x7ffffff0
    s_nop 1
    v_cndmask_b32 v11, v12, v11, vcc
    buffer_load_dword v165, v11, s[84:87], 0 offen
    v_add_u32 v2, 1536, v3
    v_mul_u32_u24 v10, 2341, v2
    v_lshrrev_b32 v10, 16, v10
    v_mul_u32_u24 v11, 28, v10
    v_sub_u32 v11, v2, v11
    v_lshlrev_b32 v150, 2, v2
    v_add_u32 v10, s36, v10
    v_cmp_gt_u32 vcc, 14, v11
    v_lshlrev_b32 v11, 2, v11
    v_add_u32 v12, 840, v11
    v_cndmask_b32 v11, v12, v11, vcc
    s_movk_i32 s44, 2688
    v_mul_lo_u32 v12, v10, s44
    v_add3_u32 v11, v11, v12, s43
    v_cmp_gt_u32 vcc, 2048, v10
    v_mov_b32 v12, 0x7ffffff0
    s_nop 1
    v_cndmask_b32 v11, v12, v11, vcc
    buffer_load_dword v166, v11, s[84:87], 0 offen
    v_add_u32 v2, 1792, v3
    v_mul_u32_u24 v10, 2341, v2
    v_lshrrev_b32 v10, 16, v10
    v_mul_u32_u24 v11, 28, v10
    v_sub_u32 v11, v2, v11
    v_lshlrev_b32 v151, 2, v2
    v_add_u32 v10, s36, v10
    v_cmp_gt_u32 vcc, 14, v11
    v_lshlrev_b32 v11, 2, v11
    v_add_u32 v12, 840, v11
    v_cndmask_b32 v11, v12, v11, vcc
    s_movk_i32 s44, 2688
    v_mul_lo_u32 v12, v10, s44
    v_add3_u32 v11, v11, v12, s43
    v_cmp_gt_u32 vcc, 2048, v10
    v_mov_b32 v12, 0x7ffffff0
    s_nop 1
    v_cndmask_b32 v11, v12, v11, vcc
    buffer_load_dword v167, v11, s[84:87], 0 offen
    v_add_u32 v2, 2048, v3
    v_mul_u32_u24 v10, 2341, v2
    v_lshrrev_b32 v10, 16, v10
    v_mul_u32_u24 v11, 28, v10
    v_sub_u32 v11, v2, v11
    v_lshlrev_b32 v152, 2, v2
    v_add_u32 v10, s36, v10
    v_cmp_gt_u32 vcc, 14, v11
    v_lshlrev_b32 v11, 2, v11
    v_add_u32 v12, 840, v11
    v_cndmask_b32 v11, v12, v11, vcc
    s_movk_i32 s44, 2688
    v_mul_lo_u32 v12, v10, s44
    v_add3_u32 v11, v11, v12, s43
    v_cmp_gt_u32 vcc, 2048, v10
    v_mov_b32 v12, 0x7ffffff0
    s_nop 1
    v_cndmask_b32 v11, v12, v11, vcc
    buffer_load_dword v168, v11, s[84:87], 0 offen
    v_add_u32 v2, 2304, v3
    v_mul_u32_u24 v10, 2341, v2
    v_lshrrev_b32 v10, 16, v10
    v_mul_u32_u24 v11, 28, v10
    v_sub_u32 v11, v2, v11
    v_lshlrev_b32 v153, 2, v2
    v_add_u32 v10, s36, v10
    v_cmp_gt_u32 vcc, 14, v11
    v_lshlrev_b32 v11, 2, v11
    v_add_u32 v12, 840, v11
    v_cndmask_b32 v11, v12, v11, vcc
    s_movk_i32 s44, 2688
    v_mul_lo_u32 v12, v10, s44
    v_add3_u32 v11, v11, v12, s43
    v_cmp_gt_u32 vcc, 2048, v10
    v_mov_b32 v12, 0x7ffffff0
    s_nop 1
    v_cndmask_b32 v11, v12, v11, vcc
    buffer_load_dword v169, v11, s[84:87], 0 offen
    v_add_u32 v2, 2560, v3
    v_mul_u32_u24 v10, 2341, v2
    v_lshrrev_b32 v10, 16, v10
    v_mul_u32_u24 v11, 28, v10
    v_sub_u32 v11, v2, v11
    v_lshlrev_b32 v154, 2, v2
    v_add_u32 v10, s36, v10
    v_cmp_gt_u32 vcc, 14, v11
    v_lshlrev_b32 v11, 2, v11
    v_add_u32 v12, 840, v11
    v_cndmask_b32 v11, v12, v11, vcc
    s_movk_i32 s44, 2688
    v_mul_lo_u32 v12, v10, s44
    v_add3_u32 v11, v11, v12, s43
    v_cmp_gt_u32 vcc, 2048, v10
    v_mov_b32 v12, 0x7ffffff0
    s_nop 1
    v_cndmask_b32 v11, v12, v11, vcc
    buffer_load_dword v170, v11, s[84:87], 0 offen
    v_add_u32 v2, 2816, v3
    v_mul_u32_u24 v10, 2341, v2
    v_lshrrev_b32 v10, 16, v10
    v_mul_u32_u24 v11, 28, v10
    v_sub_u32 v11, v2, v11
    v_lshlrev_b32 v155, 2, v2
    v_add_u32 v10, s36, v10
    v_cmp_gt_u32 vcc, 14, v11
    v_lshlrev_b32 v11, 2, v11
    v_add_u32 v12, 840, v11
    v_cndmask_b32 v11, v12, v11, vcc
    s_movk_i32 s44, 2688
    v_mul_lo_u32 v12, v10, s44
    v_add3_u32 v11, v11, v12, s43
    v_cmp_gt_u32 vcc, 2048, v10
    v_mov_b32 v12, 0x7ffffff0
    s_nop 1
    v_cndmask_b32 v11, v12, v11, vcc
    buffer_load_dword v171, v11, s[84:87], 0 offen
    v_add_u32 v2, 3072, v3
    v_mul_u32_u24 v10, 2341, v2
    v_lshrrev_b32 v10, 16, v10
    v_mul_u32_u24 v11, 28, v10
    v_sub_u32 v11, v2, v11
    v_lshlrev_b32 v156, 2, v2
    v_add_u32 v10, s36, v10
    v_cmp_gt_u32 vcc, 14, v11
    v_lshlrev_b32 v11, 2, v11
    v_add_u32 v12, 840, v11
    v_cndmask_b32 v11, v12, v11, vcc
    s_movk_i32 s44, 2688
    v_mul_lo_u32 v12, v10, s44
    v_add3_u32 v11, v11, v12, s43
    v_cmp_gt_u32 vcc, 2048, v10
    v_mov_b32 v12, 0x7ffffff0
    s_nop 1
    v_cndmask_b32 v11, v12, v11, vcc
    buffer_load_dword v172, v11, s[84:87], 0 offen
    v_add_u32 v2, 3328, v3
    v_mul_u32_u24 v10, 2341, v2
    v_lshrrev_b32 v10, 16, v10
    v_mul_u32_u24 v11, 28, v10
    v_sub_u32 v11, v2, v11
    v_lshlrev_b32 v157, 2, v2
    v_add_u32 v10, s36, v10
    v_cmp_gt_u32 vcc, 14, v11
    v_lshlrev_b32 v11, 2, v11
    v_add_u32 v12, 840, v11
    v_cndmask_b32 v11, v12, v11, vcc
    s_movk_i32 s44, 2688
    v_mul_lo_u32 v12, v10, s44
    v_add3_u32 v11, v11, v12, s43
    v_cmp_gt_u32 vcc, 2048, v10
    v_mov_b32 v12, 0x7ffffff0
    s_nop 1
    v_cndmask_b32 v11, v12, v11, vcc
    buffer_load_dword v173, v11, s[84:87], 0 offen
    v_add_u32 v2, 3584, v3
    v_mul_u32_u24 v10, 2341, v2
    v_lshrrev_b32 v10, 16, v10
    v_mul_u32_u24 v11, 28, v10
    v_sub_u32 v11, v2, v11
    v_lshlrev_b32 v158, 2, v2
    v_add_u32 v10, s36, v10
    v_cmp_gt_u32 vcc, 14, v11
    v_lshlrev_b32 v11, 2, v11
    v_add_u32 v12, 840, v11
    v_cndmask_b32 v11, v12, v11, vcc
    s_movk_i32 s44, 2688
    v_mul_lo_u32 v12, v10, s44
    v_add3_u32 v11, v11, v12, s43
    v_cmp_gt_u32 vcc, 2048, v10
    v_mov_b32 v12, 0x7ffffff0
    s_nop 1
    v_cndmask_b32 v11, v12, v11, vcc
    buffer_load_dword v174, v11, s[84:87], 0 offen
    v_add_u32 v2, 3840, v3
    v_mul_u32_u24 v10, 2341, v2
    v_lshrrev_b32 v10, 16, v10
    v_mul_u32_u24 v11, 28, v10
    v_sub_u32 v11, v2, v11
    v_lshlrev_b32 v159, 2, v2
    v_add_u32 v10, s36, v10
    v_cmp_gt_u32 vcc, 14, v11
    v_lshlrev_b32 v11, 2, v11
    v_add_u32 v12, 840, v11
    v_cndmask_b32 v11, v12, v11, vcc
    s_movk_i32 s44, 2688
    v_mul_lo_u32 v12, v10, s44
    v_add3_u32 v11, v11, v12, s43
    v_cmp_gt_u32 vcc, 2048, v10
    v_mov_b32 v12, 0x7ffffff0
    s_movk_i32 s45, 3976
    v_cmp_gt_u32 s[46:47], s45, v2
    s_nop 1
    s_and_b64 vcc, vcc, s[46:47]
    s_nop 1
    v_cndmask_b32 v11, v12, v11, vcc
    buffer_load_dword v175, v11, s[84:87], 0 offen
    s_waitcnt vmcnt(0)
    ds_write_b32 v144, v160 offset:32768
    ds_write_b32 v145, v161 offset:32768
    ds_write_b32 v146, v162 offset:32768
    ds_write_b32 v147, v163 offset:32768
    ds_write_b32 v148, v164 offset:32768
    ds_write_b32 v149, v165 offset:32768
    ds_write_b32 v150, v166 offset:32768
    ds_write_b32 v151, v167 offset:32768
    ds_write_b32 v152, v168 offset:32768
    ds_write_b32 v153, v169 offset:32768
    ds_write_b32 v154, v170 offset:32768
    ds_write_b32 v155, v171 offset:32768
    ds_write_b32 v156, v172 offset:32768
    ds_write_b32 v157, v173 offset:32768
    ds_write_b32 v158, v174 offset:32768
    v_cmp_gt_u32 vcc, 15904, v159
    s_and_saveexec_b64 s[46:47], vcc
    ds_write_b32 v159, v175 offset:32768
    s_mov_b64 exec, -1
k2nob_13:
    s_mov_b32 s37, 1049335798
    s_mov_b32 s38, 0xff800000
    s_mov_b32 s45, 0xff800000
    s_mov_b32 s39, 0x20000
    s_mov_b32 s42, 0
    buffer_load_dwordx4 v[96:99], v4, s[12:15], s42 offen
    s_add_u32 s43, s42, s39
    buffer_load_dwordx4 v[100:103], v4, s[12:15], s43 offen
    s_waitcnt vmcnt(0)
    ds_write_b128 v5, v[96:99] offset:0
    ds_write_b128 v5, v[100:103] offset:8192
    s_waitcnt lgkmcnt(0)
    s_barrier
    s_mov_b32 s41, 0
k2loop_14:
    s_add_u32 s42, s41, 1
    s_cmp_ge_u32 s42, 16
    s_cbranch_scc1 k2nl_15
    s_lshl_b32 s42, s42, 12
    buffer_load_dwordx4 v[96:99], v4, s[12:15], s42 offen
    s_add_u32 s43, s42, s39
    buffer_load_dwordx4 v[100:103], v4, s[12:15], s43 offen
k2nl_15:
    ds_read_b128 v[80:83], v6 offset:0
    ds_read_b128 v[84:87], v6 offset:1024
    ds_read_b128 v[120:123], v6 offset:2048
    ds_read_b128 v[124:127], v6 offset:3072
    ds_read_b128 v[88:91], v6 offset:8192
    ds_read_b128 v[92:95], v6 offset:9216
    ds_read_b128 v[128:131], v6 offset:10240
    ds_read_b128 v[132:135], v6 offset:11264
    s_waitcnt lgkmcnt(6)
    v_mfma_f32_32x32x16_bf16 v[32:47], v[80:83], v[16:19], 0
    v_mfma_f32_32x32x16_bf16 v[32:47], v[84:87], v[20:23], v[32:47]
    s_waitcnt lgkmcnt(4)
    v_mfma_f32_32x32x16_bf16 v[104:119], v[120:123], v[16:19], 0
    v_mfma_f32_32x32x16_bf16 v[104:119], v[124:127], v[20:23], v[104:119]
    s_nop 9
    v_max3_f32 v10, v32, v33, v34
    v_max3_f32 v10, v10, v35, v36
    v_max3_f32 v10, v10, v37, v38
    v_max3_f32 v10, v10, v39, v40
    v_max3_f32 v10, v10, v41, v42
    v_max3_f32 v10, v10, v43, v44
    v_max3_f32 v10, v10, v45, v46
    v_max3_f32 v10, v10, v47, v104
    v_max3_f32 v10, v10, v105, v106
    v_max3_f32 v10, v10, v107, v108
    v_max3_f32 v10, v10, v109, v110
    v_max3_f32 v10, v10, v111, v112
    v_max3_f32 v10, v10, v113, v114
    v_max3_f32 v10, v10, v115, v116
    v_max3_f32 v10, v10, v117, v118
    v_max_f32 v10, v10, v119
    v_mov_b32 v11, v10
    s_nop 1
    v_permlane32_swap_b32 v10, v11
    v_max_f32 v10, v10, v11
    v_cmp_lt_f32 vcc, s38, v10
    s_cbranch_vccz k2sk_16
    v_max_f32 v10, s45, v10
    v_add_f32 v12, v9, v10
    v_and_b32 v12, 0xffff0000, v12
    v_sub_f32 v10, v12, v9
    v_mov_b32 v9, v12
    v_exp_f32 v11, -v10
    v_xor_b32 v12, 0x80000000, v12
    v_lshrrev_b32 v12, 16, v12
    s_mov_b32 exec_lo, 0
    v_mov_b32 v22, v12
    s_mov_b32 exec_lo, -1
    v_mul_f32 v64, v64, v11
    v_sub_f32 v32, v32, v10
    v_sub_f32 v104, v104, v10
    v_mul_f32 v65, v65, v11
    v_sub_f32 v33, v33, v10
    v_sub_f32 v105, v105, v10
    v_mul_f32 v66, v66, v11
    v_sub_f32 v34, v34, v10
    v_sub_f32 v106, v106, v10
    v_mul_f32 v67, v67, v11
    v_sub_f32 v35, v35, v10
    v_sub_f32 v107, v107, v10
    v_mul_f32 v68, v68, v11
    v_sub_f32 v36, v36, v10
    v_sub_f32 v108, v108, v10
    v_mul_f32 v69, v69, v11
    v_sub_f32 v37, v37, v10
    v_sub_f32 v109, v109, v10
    v_mul_f32 v70, v70, v11
    v_sub_f32 v38, v38, v10
    v_sub_f32 v110, v110, v10
    v_mul_f32 v71, v71, v11
    v_sub_f32 v39, v39, v10
    v_sub_f32 v111, v111, v10
    v_mul_f32 v72, v72, v11
    v_sub_f32 v40, v40, v10
    v_sub_f32 v112, v112, v10
    v_mul_f32 v73, v73, v11
    v_sub_f32 v41, v41, v10
    v_sub_f32 v113, v113, v10
    v_mul_f32 v74, v74, v11
    v_sub_f32 v42, v42, v10
    v_sub_f32 v114, v114, v10
    v_mul_f32 v75, v75, v11
    v_sub_f32 v43, v43, v10
    v_sub_f32 v115, v115, v10
    v_mul_f32 v76, v76, v11
    v_sub_f32 v44, v44, v10
    v_sub_f32 v116, v116, v10
    v_mul_f32 v77, v77, v11
    v_sub_f32 v45, v45, v10
    v_sub_f32 v117, v117, v10
    v_mul_f32 v78, v78, v11
    v_sub_f32 v46, v46, v10
    v_sub_f32 v118, v118, v10
    v_mul_f32 v79, v79, v11
    v_sub_f32 v47, v47, v10
    v_sub_f32 v119, v119, v10
k2sk_16:
    s_mov_b32 s38, 0x41000000
    s_mov_b32 s45, 0
    v_exp_f32 v32, v32
    v_exp_f32 v33, v33
    v_exp_f32 v34, v34
    v_exp_f32 v35, v35
    v_exp_f32 v36, v36
    v_exp_f32 v37, v37
    v_exp_f32 v38, v38
    v_exp_f32 v39, v39
    v_exp_f32 v40, v40
    v_exp_f32 v41, v41
    v_exp_f32 v42, v42
    v_exp_f32 v43, v43
    v_exp_f32 v44, v44
    v_exp_f32 v45, v45
    v_exp_f32 v46, v46
    v_exp_f32 v47, v47
    s_nop 0
    v_cvt_pk_bf16_f32 v48, v32, v33
    v_cvt_pk_bf16_f32 v49, v34, v35
    v_cvt_pk_bf16_f32 v50, v36, v37
    v_cvt_pk_bf16_f32 v51, v38, v39
    v_cvt_pk_bf16_f32 v52, v40, v41
    v_cvt_pk_bf16_f32 v53, v42, v43
    v_cvt_pk_bf16_f32 v54, v44, v45
    v_cvt_pk_bf16_f32 v55, v46, v47
    s_waitcnt lgkmcnt(0)
    s_nop 1
    v_mfma_f32_32x32x16_bf16 v[64:79], v[88:91], v[48:51], v[64:79]
    v_mfma_f32_32x32x16_bf16 v[64:79], v[92:95], v[52:55], v[64:79]
    v_exp_f32 v104, v104
    v_exp_f32 v105, v105
    v_exp_f32 v106, v106
    v_exp_f32 v107, v107
    v_exp_f32 v108, v108
    v_exp_f32 v109, v109
    v_exp_f32 v110, v110
    v_exp_f32 v111, v111
    v_exp_f32 v112, v112
    v_exp_f32 v113, v113
    v_exp_f32 v114, v114
    v_exp_f32 v115, v115
    v_exp_f32 v116, v116
    v_exp_f32 v117, v117
    v_exp_f32 v118, v118
    v_exp_f32 v119, v119
    s_nop 0
    v_cvt_pk_bf16_f32 v136, v104, v105
    v_cvt_pk_bf16_f32 v137, v106, v107
    v_cvt_pk_bf16_f32 v138, v108, v109
    v_cvt_pk_bf16_f32 v139, v110, v111
    v_cvt_pk_bf16_f32 v140, v112, v113
    v_cvt_pk_bf16_f32 v141, v114, v115
    v_cvt_pk_bf16_f32 v142, v116, v117
    v_cvt_pk_bf16_f32 v143, v118, v119
    s_waitcnt lgkmcnt(0)
    s_nop 1
    v_mfma_f32_32x32x16_bf16 v[64:79], v[128:131], v[136:139], v[64:79]
    v_mfma_f32_32x32x16_bf16 v[64:79], v[132:135], v[140:143], v[64:79]
    s_waitcnt vmcnt(0)
    ds_write_b128 v5, v[96:99] offset:16384
    ds_write_b128 v5, v[100:103] offset:24576
    s_waitcnt lgkmcnt(0)
    s_barrier
    s_add_u32 s41, s41, 1
    s_add_u32 s42, s41, 1
    s_cmp_ge_u32 s42, 16
    s_cbranch_scc1 k2nl_17
    s_lshl_b32 s42, s42, 12
    buffer_load_dwordx4 v[96:99], v4, s[12:15], s42 offen
    s_add_u32 s43, s42, s39
    buffer_load_dwordx4 v[100:103], v4, s[12:15], s43 offen
k2nl_17:
    ds_read_b128 v[80:83], v6 offset:16384
    ds_read_b128 v[84:87], v6 offset:17408
    ds_read_b128 v[120:123], v6 offset:18432
    ds_read_b128 v[124:127], v6 offset:19456
    ds_read_b128 v[88:91], v6 offset:24576
    ds_read_b128 v[92:95], v6 offset:25600
    ds_read_b128 v[128:131], v6 offset:26624
    ds_read_b128 v[132:135], v6 offset:27648
    s_waitcnt lgkmcnt(6)
    v_mfma_f32_32x32x16_bf16 v[32:47], v[80:83], v[16:19], 0
    v_mfma_f32_32x32x16_bf16 v[32:47], v[84:87], v[20:23], v[32:47]
    s_waitcnt lgkmcnt(4)
    v_mfma_f32_32x32x16_bf16 v[104:119], v[120:123], v[16:19], 0
    v_mfma_f32_32x32x16_bf16 v[104:119], v[124:127], v[20:23], v[104:119]
    s_nop 9
    v_max3_f32 v10, v32, v33, v34
    v_max3_f32 v10, v10, v35, v36
    v_max3_f32 v10, v10, v37, v38
    v_max3_f32 v10, v10, v39, v40
    v_max3_f32 v10, v10, v41, v42
    v_max3_f32 v10, v10, v43, v44
    v_max3_f32 v10, v10, v45, v46
    v_max3_f32 v10, v10, v47, v104
    v_max3_f32 v10, v10, v105, v106
    v_max3_f32 v10, v10, v107, v108
    v_max3_f32 v10, v10, v109, v110
    v_max3_f32 v10, v10, v111, v112
    v_max3_f32 v10, v10, v113, v114
    v_max3_f32 v10, v10, v115, v116
    v_max3_f32 v10, v10, v117, v118
    v_max_f32 v10, v10, v119
    v_mov_b32 v11, v10
    s_nop 1
    v_permlane32_swap_b32 v10, v11
    v_max_f32 v10, v10, v11
    v_cmp_lt_f32 vcc, s38, v10
    s_cbranch_vccz k2sk_18
    v_max_f32 v10, s45, v10
    v_add_f32 v12, v9, v10
    v_and_b32 v12, 0xffff0000, v12
    v_sub_f32 v10, v12, v9
    v_mov_b32 v9, v12
    v_exp_f32 v11, -v10
    v_xor_b32 v12, 0x80000000, v12
    v_lshrrev_b32 v12, 16, v12
    s_mov_b32 exec_lo, 0
    v_mov_b32 v22, v12
    s_mov_b32 exec_lo, -1
    v_mul_f32 v64, v64, v11
    v_sub_f32 v32, v32, v10
    v_sub_f32 v104, v104, v10
    v_mul_f32 v65, v65, v11
    v_sub_f32 v33, v33, v10
    v_sub_f32 v105, v105, v10
    v_mul_f32 v66, v66, v11
    v_sub_f32 v34, v34, v10
    v_sub_f32 v106, v106, v10
    v_mul_f32 v67, v67, v11
    v_sub_f32 v35, v35, v10
    v_sub_f32 v107, v107, v10
    v_mul_f32 v68, v68, v11
    v_sub_f32 v36, v36, v10
    v_sub_f32 v108, v108, v10
    v_mul_f32 v69, v69, v11
    v_sub_f32 v37, v37, v10
    v_sub_f32 v109, v109, v10
    v_mul_f32 v70, v70, v11
    v_sub_f32 v38, v38, v10
    v_sub_f32 v110, v110, v10
    v_mul_f32 v71, v71, v11
    v_sub_f32 v39, v39, v10
    v_sub_f32 v111, v111, v10
    v_mul_f32 v72, v72, v11
    v_sub_f32 v40, v40, v10
    v_sub_f32 v112, v112, v10
    v_mul_f32 v73, v73, v11
    v_sub_f32 v41, v41, v10
    v_sub_f32 v113, v113, v10
    v_mul_f32 v74, v74, v11
    v_sub_f32 v42, v42, v10
    v_sub_f32 v114, v114, v10
    v_mul_f32 v75, v75, v11
    v_sub_f32 v43, v43, v10
    v_sub_f32 v115, v115, v10
    v_mul_f32 v76, v76, v11
    v_sub_f32 v44, v44, v10
    v_sub_f32 v116, v116, v10
    v_mul_f32 v77, v77, v11
    v_sub_f32 v45, v45, v10
    v_sub_f32 v117, v117, v10
    v_mul_f32 v78, v78, v11
    v_sub_f32 v46, v46, v10
    v_sub_f32 v118, v118, v10
    v_mul_f32 v79, v79, v11
    v_sub_f32 v47, v47, v10
    v_sub_f32 v119, v119, v10
k2sk_18:
    s_mov_b32 s38, 0x41000000
    s_mov_b32 s45, 0
    v_exp_f32 v32, v32
    v_exp_f32 v33, v33
    v_exp_f32 v34, v34
    v_exp_f32 v35, v35
    v_exp_f32 v36, v36
    v_exp_f32 v37, v37
    v_exp_f32 v38, v38
    v_exp_f32 v39, v39
    v_exp_f32 v40, v40
    v_exp_f32 v41, v41
    v_exp_f32 v42, v42
    v_exp_f32 v43, v43
    v_exp_f32 v44, v44
    v_exp_f32 v45, v45
    v_exp_f32 v46, v46
    v_exp_f32 v47, v47
    s_nop 0
    v_cvt_pk_bf16_f32 v48, v32, v33
    v_cvt_pk_bf16_f32 v49, v34, v35
    v_cvt_pk_bf16_f32 v50, v36, v37
    v_cvt_pk_bf16_f32 v51, v38, v39
    v_cvt_pk_bf16_f32 v52, v40, v41
    v_cvt_pk_bf16_f32 v53, v42, v43
    v_cvt_pk_bf16_f32 v54, v44, v45
    v_cvt_pk_bf16_f32 v55, v46, v47
    s_waitcnt lgkmcnt(0)
    s_nop 1
    v_mfma_f32_32x32x16_bf16 v[64:79], v[88:91], v[48:51], v[64:79]
    v_mfma_f32_32x32x16_bf16 v[64:79], v[92:95], v[52:55], v[64:79]
    v_exp_f32 v104, v104
    v_exp_f32 v105, v105
    v_exp_f32 v106, v106
    v_exp_f32 v107, v107
    v_exp_f32 v108, v108
    v_exp_f32 v109, v109
    v_exp_f32 v110, v110
    v_exp_f32 v111, v111
    v_exp_f32 v112, v112
    v_exp_f32 v113, v113
    v_exp_f32 v114, v114
    v_exp_f32 v115, v115
    v_exp_f32 v116, v116
    v_exp_f32 v117, v117
    v_exp_f32 v118, v118
    v_exp_f32 v119, v119
    s_nop 0
    v_cvt_pk_bf16_f32 v136, v104, v105
    v_cvt_pk_bf16_f32 v137, v106, v107
    v_cvt_pk_bf16_f32 v138, v108, v109
    v_cvt_pk_bf16_f32 v139, v110, v111
    v_cvt_pk_bf16_f32 v140, v112, v113
    v_cvt_pk_bf16_f32 v141, v114, v115
    v_cvt_pk_bf16_f32 v142, v116, v117
    v_cvt_pk_bf16_f32 v143, v118, v119
    s_waitcnt lgkmcnt(0)
    s_nop 1
    v_mfma_f32_32x32x16_bf16 v[64:79], v[128:131], v[136:139], v[64:79]
    v_mfma_f32_32x32x16_bf16 v[64:79], v[132:135], v[140:143], v[64:79]
    s_waitcnt vmcnt(0)
    ds_write_b128 v5, v[96:99] offset:0
    ds_write_b128 v5, v[100:103] offset:8192
    s_waitcnt lgkmcnt(0)
    s_barrier
    s_add_u32 s41, s41, 1
    s_cmp_lt_u32 s41, 16
    s_cbranch_scc1 k2loop_14
    s_nop 15
    s_cmp_ge_u32 s6, 4
    s_cbranch_scc1 k2up_19
    s_barrier
    v_lshlrev_b32 v2, 4, v1
    s_mul_i32 s36, s7, 5120
    v_add_u32 v2, s36, v2
    ds_read_b128 v[32:35], v2 offset:0
    ds_read_b128 v[36:39], v2 offset:1024
    ds_read_b128 v[40:43], v2 offset:2048
    ds_read_b128 v[44:47], v2 offset:3072
    v_lshlrev_b32 v3, 2, v1
    v_add_u32 v3, s36, v3
    ds_read_b32 v10, v3 offset:4096
    s_add_u32 s16, s20, 2359296
    s_addc_u32 s17, s21, 0
    s_mov_b32 s18, 8192
    s_mov_b32 s19, 0x00020000
    v_lshlrev_b32 v2, 2, v7
    buffer_load_dword v11, v2, s[16:19], 0 offen
    s_waitcnt lgkmcnt(0)
    v_max_f32 v12, v9, v10
    v_sub_f32 v9, v9, v12
    v_sub_f32 v10, v10, v12
    v_exp_f32 v9, v9
    v_exp_f32 v10, v10
    s_nop 0
    v_mul_f32 v64, v64, v9
    v_fmac_f32 v64, v32, v10
    v_mul_f32 v65, v65, v9
    v_fmac_f32 v65, v33, v10
    v_mul_f32 v66, v66, v9
    v_fmac_f32 v66, v34, v10
    v_mul_f32 v67, v67, v9
    v_fmac_f32 v67, v35, v10
    v_mul_f32 v68, v68, v9
    v_fmac_f32 v68, v36, v10
    v_mul_f32 v69, v69, v9
    v_fmac_f32 v69, v37, v10
    v_mul_f32 v70, v70, v9
    v_fmac_f32 v70, v38, v10
    v_mul_f32 v71, v71, v9
    v_fmac_f32 v71, v39, v10
    v_mul_f32 v72, v72, v9
    v_fmac_f32 v72, v40, v10
    v_mul_f32 v73, v73, v9
    v_fmac_f32 v73, v41, v10
    v_mul_f32 v74, v74, v9
    v_fmac_f32 v74, v42, v10
    v_mul_f32 v75, v75, v9
    v_fmac_f32 v75, v43, v10
    v_mul_f32 v76, v76, v9
    v_fmac_f32 v76, v44, v10
    v_mul_f32 v77, v77, v9
    v_fmac_f32 v77, v45, v10
    v_mul_f32 v78, v78, v9
    v_fmac_f32 v78, v46, v10
    v_mul_f32 v79, v79, v9
    v_fmac_f32 v79, v47, v10
    v_mov_b32 v2, v76
    v_mov_b32 v3, v76
    s_nop 1
    v_permlane32_swap_b32 v2, v3
    v_rcp_f32 v3, v3
    s_waitcnt vmcnt(0)
    v_mul_f32 v11, 0xbfb8aa3b, v11
    v_exp_f32 v11, v11
    s_nop 0
    v_add_f32 v11, 1.0, v11
    v_rcp_f32 v11, v11
    s_nop 0
    v_mul_f32 v3, v3, v11
    s_add_u32 s16, s20, 9437184
    s_addc_u32 s17, s21, 0
    s_mov_b32 s18, 3670016
    s_mov_b32 s19, 0x00020000
    s_movk_i32 s36, 1792
    v_mul_lo_u32 v2, v7, s36
    s_mul_i32 s36, s4, 56
    v_add_u32 v2, s36, v2
    v_lshl_add_u32 v2, v8, 3, v2
    v_mul_f32 v64, v64, v3
    v_mul_f32 v65, v65, v3
    v_mul_f32 v66, v66, v3
    v_mul_f32 v67, v67, v3
    v_cvt_pk_bf16_f32 v48, v64, v65
    v_cvt_pk_bf16_f32 v49, v66, v67
    buffer_store_dwordx2 v[48:49], v2, s[16:19], 0 offen offset:0
    v_mul_f32 v68, v68, v3
    v_mul_f32 v69, v69, v3
    v_mul_f32 v70, v70, v3
    v_mul_f32 v71, v71, v3
    v_cvt_pk_bf16_f32 v50, v68, v69
    v_cvt_pk_bf16_f32 v51, v70, v71
    buffer_store_dwordx2 v[50:51], v2, s[16:19], 0 offen offset:16
    v_mul_f32 v72, v72, v3
    v_mul_f32 v73, v73, v3
    v_mul_f32 v74, v74, v3
    v_mul_f32 v75, v75, v3
    v_cvt_pk_bf16_f32 v52, v72, v73
    v_cvt_pk_bf16_f32 v53, v74, v75
    buffer_store_dwordx2 v[52:53], v2, s[16:19], 0 offen offset:32
    v_mul_f32 v76, v76, v3
    v_mul_f32 v77, v77, v3
    v_mul_f32 v78, v78, v3
    v_mul_f32 v79, v79, v3
    v_cvt_pk_bf16_f32 v54, v76, v77
    v_cvt_pk_bf16_f32 v55, v78, v79
    s_mov_b32 exec_hi, 0
    buffer_store_dwordx2 v[54:55], v2, s[16:19], 0 offen offset:48
    s_mov_b64 exec, -1
    s_branch k2end_12
k2up_19:
    v_lshlrev_b32 v2, 4, v1
    s_mul_i32 s36, s7, 5120
    v_add_u32 v2, s36, v2
    ds_write_b128 v2, v[64:67] offset:0
    ds_write_b128 v2, v[68:71] offset:1024
    ds_write_b128 v2, v[72:75] offset:2048
    ds_write_b128 v2, v[76:79] offset:3072
    v_lshlrev_b32 v3, 2, v1
    v_add_u32 v3, s36, v3
    ds_write_b32 v3, v9 offset:4096
    s_waitcnt lgkmcnt(0)
    s_barrier
    v_lshrrev_b32 v2, 1, v1
    v_add_u32 v7, s35, v2
    s_lshl_b32 s36, s7, 5
    v_add_u32 v2, s36, v2
    v_mul_u32_u24 v2, 112, v2
    v_and_b32 v3, 1, v1
    v_mul_u32_u24 v3, 28, v3
    v_add_u32 v2, v2, v3
    ds_read_b32 v144, v2 offset:34336
    ds_read_b32 v208, v2 offset:34392
    ds_read_b32 v145, v2 offset:34340
    ds_read_b32 v209, v2 offset:34396
    ds_read_b32 v146, v2 offset:34344
    ds_read_b32 v210, v2 offset:34400
    ds_read_b32 v147, v2 offset:34348
    ds_read_b32 v211, v2 offset:34404
    ds_read_b32 v148, v2 offset:34352
    ds_read_b32 v212, v2 offset:34408
    ds_read_b32 v149, v2 offset:34356
    ds_read_b32 v213, v2 offset:34412
    ds_read_b32 v150, v2 offset:34360
    ds_read_b32 v214, v2 offset:34416
    s_waitcnt lgkmcnt(0)
    ds_read_b32 v152, v2 offset:34112
    ds_read_b32 v216, v2 offset:34168
    ds_read_b32 v153, v2 offset:34116
    ds_read_b32 v217, v2 offset:34172
    ds_read_b32 v154, v2 offset:34120
    ds_read_b32 v218, v2 offset:34176
    ds_read_b32 v155, v2 offset:34124
    ds_read_b32 v219, v2 offset:34180
    ds_read_b32 v156, v2 offset:34128
    ds_read_b32 v220, v2 offset:34184
    ds_read_b32 v157, v2 offset:34132
    ds_read_b32 v221, v2 offset:34188
    ds_read_b32 v158, v2 offset:34136
    ds_read_b32 v222, v2 offset:34192
    s_waitcnt lgkmcnt(0)
    ds_read_b32 v160, v2 offset:33888
    ds_read_b32 v224, v2 offset:33944
    ds_read_b32 v161, v2 offset:33892
    ds_read_b32 v225, v2 offset:33948
    ds_read_b32 v162, v2 offset:33896
    ds_read_b32 v226, v2 offset:33952
    ds_read_b32 v163, v2 offset:33900
    ds_read_b32 v227, v2 offset:33956
    ds_read_b32 v164, v2 offset:33904
    ds_read_b32 v228, v2 offset:33960
    ds_read_b32 v165, v2 offset:33908
    ds_read_b32 v229, v2 offset:33964
    ds_read_b32 v166, v2 offset:33912
    ds_read_b32 v230, v2 offset:33968
    s_waitcnt lgkmcnt(0)
    ds_read_b32 v168, v2 offset:33664
    ds_read_b32 v232, v2 offset:33720
    ds_read_b32 v169, v2 offset:33668
    ds_read_b32 v233, v2 offset:33724
    ds_read_b32 v170, v2 offset:33672
    ds_read_b32 v234, v2 offset:33728
    ds_read_b32 v171, v2 offset:33676
    ds_read_b32 v235, v2 offset:33732
    ds_read_b32 v172, v2 offset:33680
    ds_read_b32 v236, v2 offset:33736
    ds_read_b32 v173, v2 offset:33684
    ds_read_b32 v237, v2 offset:33740
    ds_read_b32 v174, v2 offset:33688
    ds_read_b32 v238, v2 offset:33744
    s_waitcnt lgkmcnt(0)
    ds_read_b32 v176, v2 offset:33440
    ds_read_b32 v240, v2 offset:33496
    ds_read_b32 v177, v2 offset:33444
    ds_read_b32 v241, v2 offset:33500
    ds_read_b32 v178, v2 offset:33448
    ds_read_b32 v242, v2 offset:33504
    ds_read_b32 v179, v2 offset:33452
    ds_read_b32 v243, v2 offset:33508
    ds_read_b32 v180, v2 offset:33456
    ds_read_b32 v244, v2 offset:33512
    ds_read_b32 v181, v2 offset:33460
    ds_read_b32 v245, v2 offset:33516
    ds_read_b32 v182, v2 offset:33464
    ds_read_b32 v246, v2 offset:33520
    s_waitcnt lgkmcnt(0)
    ds_read_b32 v184, v2 offset:33216
    ds_read_b32 v248, v2 offset:33272
    ds_read_b32 v185, v2 offset:33220
    ds_read_b32 v249, v2 offset:33276
    ds_read_b32 v186, v2 offset:33224
    ds_read_b32 v250, v2 offset:33280
    ds_read_b32 v187, v2 offset:33228
    ds_read_b32 v251, v2 offset:33284
    ds_read_b32 v188, v2 offset:33232
    ds_read_b32 v252, v2 offset:33288
    ds_read_b32 v189, v2 offset:33236
    ds_read_b32 v253, v2 offset:33292
    ds_read_b32 v190, v2 offset:33240
    ds_read_b32 v254, v2 offset:33296
    s_waitcnt lgkmcnt(0)
    ds_read_b32 v192, v2 offset:32992
    ds_read_b32 v80, v2 offset:33048
    ds_read_b32 v193, v2 offset:32996
    ds_read_b32 v81, v2 offset:33052
    ds_read_b32 v194, v2 offset:33000
    ds_read_b32 v82, v2 offset:33056
    ds_read_b32 v195, v2 offset:33004
    ds_read_b32 v83, v2 offset:33060
    ds_read_b32 v196, v2 offset:33008
    ds_read_b32 v84, v2 offset:33064
    ds_read_b32 v197, v2 offset:33012
    ds_read_b32 v85, v2 offset:33068
    ds_read_b32 v198, v2 offset:33016
    ds_read_b32 v86, v2 offset:33072
    s_waitcnt lgkmcnt(0)
    ds_read_b32 v200, v2 offset:32768
    ds_read_b32 v88, v2 offset:32824
    ds_read_b32 v201, v2 offset:32772
    ds_read_b32 v89, v2 offset:32828
    ds_read_b32 v202, v2 offset:32776
    ds_read_b32 v90, v2 offset:32832
    ds_read_b32 v203, v2 offset:32780
    ds_read_b32 v91, v2 offset:32836
    ds_read_b32 v204, v2 offset:32784
    ds_read_b32 v92, v2 offset:32840
    ds_read_b32 v205, v2 offset:32788
    ds_read_b32 v93, v2 offset:32844
    ds_read_b32 v206, v2 offset:32792
    ds_read_b32 v94, v2 offset:32848
    s_waitcnt lgkmcnt(0)
    s_add_u32 s16, s20, 2359296
    s_addc_u32 s17, s21, 0
    s_mov_b32 s18, 8192
    s_mov_b32 s19, 0x00020000
    v_lshlrev_b32 v2, 2, v7
    buffer_load_dword v11, v2, s[16:19], 0 offen
    s_waitcnt vmcnt(0)
    v_mov_b32 v32, 0
    v_dot2_f32_bf16 v32, v24, v144, v32
    v_dot2_f32_bf16 v32, v25, v145, v32
    v_dot2_f32_bf16 v32, v26, v146, v32
    v_dot2_f32_bf16 v32, v27, v147, v32
    v_dot2_f32_bf16 v32, v28, v148, v32
    v_dot2_f32_bf16 v32, v29, v149, v32
    v_dot2_f32_bf16 v32, v30, v150, v32
    v_mov_b32 v33, 0
    v_dot2_f32_bf16 v33, v24, v152, v33
    v_dot2_f32_bf16 v33, v25, v153, v33
    v_dot2_f32_bf16 v33, v26, v154, v33
    v_dot2_f32_bf16 v33, v27, v155, v33
    v_dot2_f32_bf16 v33, v28, v156, v33
    v_dot2_f32_bf16 v33, v29, v157, v33
    v_dot2_f32_bf16 v33, v30, v158, v33
    v_mov_b32 v34, 0
    v_dot2_f32_bf16 v34, v24, v160, v34
    v_dot2_f32_bf16 v34, v25, v161, v34
    v_dot2_f32_bf16 v34, v26, v162, v34
    v_dot2_f32_bf16 v34, v27, v163, v34
    v_dot2_f32_bf16 v34, v28, v164, v34
    v_dot2_f32_bf16 v34, v29, v165, v34
    v_dot2_f32_bf16 v34, v30, v166, v34
    v_mov_b32 v35, 0
    v_dot2_f32_bf16 v35, v24, v168, v35
    v_dot2_f32_bf16 v35, v25, v169, v35
    v_dot2_f32_bf16 v35, v26, v170, v35
    v_dot2_f32_bf16 v35, v27, v171, v35
    v_dot2_f32_bf16 v35, v28, v172, v35
    v_dot2_f32_bf16 v35, v29, v173, v35
    v_dot2_f32_bf16 v35, v30, v174, v35
    v_mov_b32 v36, 0
    v_dot2_f32_bf16 v36, v24, v176, v36
    v_dot2_f32_bf16 v36, v25, v177, v36
    v_dot2_f32_bf16 v36, v26, v178, v36
    v_dot2_f32_bf16 v36, v27, v179, v36
    v_dot2_f32_bf16 v36, v28, v180, v36
    v_dot2_f32_bf16 v36, v29, v181, v36
    v_dot2_f32_bf16 v36, v30, v182, v36
    v_mov_b32 v37, 0
    v_dot2_f32_bf16 v37, v24, v184, v37
    v_dot2_f32_bf16 v37, v25, v185, v37
    v_dot2_f32_bf16 v37, v26, v186, v37
    v_dot2_f32_bf16 v37, v27, v187, v37
    v_dot2_f32_bf16 v37, v28, v188, v37
    v_dot2_f32_bf16 v37, v29, v189, v37
    v_dot2_f32_bf16 v37, v30, v190, v37
    v_mov_b32 v38, 0
    v_dot2_f32_bf16 v38, v24, v192, v38
    v_dot2_f32_bf16 v38, v25, v193, v38
    v_dot2_f32_bf16 v38, v26, v194, v38
    v_dot2_f32_bf16 v38, v27, v195, v38
    v_dot2_f32_bf16 v38, v28, v196, v38
    v_dot2_f32_bf16 v38, v29, v197, v38
    v_dot2_f32_bf16 v38, v30, v198, v38
    v_mov_b32 v39, 0
    v_dot2_f32_bf16 v39, v24, v200, v39
    v_dot2_f32_bf16 v39, v25, v201, v39
    v_dot2_f32_bf16 v39, v26, v202, v39
    v_dot2_f32_bf16 v39, v27, v203, v39
    v_dot2_f32_bf16 v39, v28, v204, v39
    v_dot2_f32_bf16 v39, v29, v205, v39
    v_dot2_f32_bf16 v39, v30, v206, v39
    s_nop 1
    v_add_f32_dpp v40, v32, v32 quad_perm:[1,0,3,2] row_mask:0xf bank_mask:0xf
    v_mul_f32 v32, s37, v40
    v_cmp_le_u32 vcc, 0, v7
    v_mov_b32 v10, 0xf149f2ca
    s_nop 0
    v_cndmask_b32 v32, v10, v32, vcc
    v_add_f32_dpp v40, v33, v33 quad_perm:[1,0,3,2] row_mask:0xf bank_mask:0xf
    v_mul_f32 v33, s37, v40
    v_cmp_le_u32 vcc, 2, v7
    v_mov_b32 v10, 0xf149f2ca
    s_nop 0
    v_cndmask_b32 v33, v10, v33, vcc
    v_add_f32_dpp v40, v34, v34 quad_perm:[1,0,3,2] row_mask:0xf bank_mask:0xf
    v_mul_f32 v34, s37, v40
    v_cmp_le_u32 vcc, 4, v7
    v_mov_b32 v10, 0xf149f2ca
    s_nop 0
    v_cndmask_b32 v34, v10, v34, vcc
    v_add_f32_dpp v40, v35, v35 quad_perm:[1,0,3,2] row_mask:0xf bank_mask:0xf
    v_mul_f32 v35, s37, v40
    v_cmp_le_u32 vcc, 6, v7
    v_mov_b32 v10, 0xf149f2ca
    s_nop 0
    v_cndmask_b32 v35, v10, v35, vcc
    v_add_f32_dpp v40, v36, v36 quad_perm:[1,0,3,2] row_mask:0xf bank_mask:0xf
    v_mul_f32 v36, s37, v40
    v_cmp_le_u32 vcc, 8, v7
    v_mov_b32 v10, 0xf149f2ca
    s_nop 0
    v_cndmask_b32 v36, v10, v36, vcc
    v_add_f32_dpp v40, v37, v37 quad_perm:[1,0,3,2] row_mask:0xf bank_mask:0xf
    v_mul_f32 v37, s37, v40
    v_cmp_le_u32 vcc, 10, v7
    v_mov_b32 v10, 0xf149f2ca
    s_nop 0
    v_cndmask_b32 v37, v10, v37, vcc
    v_add_f32_dpp v40, v38, v38 quad_perm:[1,0,3,2] row_mask:0xf bank_mask:0xf
    v_mul_f32 v38, s37, v40
    v_cmp_le_u32 vcc, 12, v7
    v_mov_b32 v10, 0xf149f2ca
    s_nop 0
    v_cndmask_b32 v38, v10, v38, vcc
    v_add_f32_dpp v40, v39, v39 quad_perm:[1,0,3,2] row_mask:0xf bank_mask:0xf
    v_mul_f32 v39, s37, v40
    v_cmp_le_u32 vcc, 14, v7
    v_mov_b32 v10, 0xf149f2ca
    s_nop 0
    v_cndmask_b32 v39, v10, v39, vcc
    v_max3_f32 v10, v32, v33, v34
    v_max3_f32 v10, v10, v35, v36
    v_max3_f32 v10, v10, v37, v38
    v_max_f32 v10, v10, v39
    v_sub_f32 v32, v32, v10
    v_exp_f32 v32, v32
    v_sub_f32 v33, v33, v10
    v_exp_f32 v33, v33
    v_sub_f32 v34, v34, v10
    v_exp_f32 v34, v34
    v_sub_f32 v35, v35, v10
    v_exp_f32 v35, v35
    v_sub_f32 v36, v36, v10
    v_exp_f32 v36, v36
    v_sub_f32 v37, v37, v10
    v_exp_f32 v37, v37
    v_sub_f32 v38, v38, v10
    v_exp_f32 v38, v38
    v_sub_f32 v39, v39, v10
    v_exp_f32 v39, v39
    s_nop 0
    v_add_f32 v10, v32, v33
    v_add_f32 v10, v10, v34
    v_add_f32 v10, v10, v35
    v_add_f32 v10, v10, v36
    v_add_f32 v10, v10, v37
    v_add_f32 v10, v10, v38
    v_add_f32 v10, v10, v39
    v_rcp_f32 v10, v10
    v_mul_f32 v11, 0x3fb8aa3b, v11
    v_exp_f32 v11, v11
    s_nop 0
    v_add_f32 v11, 1.0, v11
    v_rcp_f32 v11, v11
    s_nop 0
    v_mul_f32 v10, v10, v11
    v_mul_f32 v32, v32, v10
    v_mul_f32 v33, v33, v10
    v_mul_f32 v34, v34, v10
    v_mul_f32 v35, v35, v10
    v_mul_f32 v36, v36, v10
    v_mul_f32 v37, v37, v10
    v_mul_f32 v38, v38, v10
    v_mul_f32 v39, v39, v10
    v_mov_b32 v104, 0
    v_mov_b32 v105, 0
    v_mov_b32 v106, 0
    v_mov_b32 v107, 0
    v_mov_b32 v108, 0
    v_mov_b32 v109, 0
    v_mov_b32 v110, 0
    v_mov_b32 v111, 0
    v_mov_b32 v112, 0
    v_mov_b32 v113, 0
    v_mov_b32 v114, 0
    v_mov_b32 v115, 0
    v_mov_b32 v116, 0
    v_mov_b32 v117, 0
    v_lshlrev_b32 v2, 16, v208
    v_and_b32 v3, 0xffff0000, v208
    v_fmac_f32 v104, v2, v32
    v_fmac_f32 v105, v3, v32
    v_lshlrev_b32 v2, 16, v209
    v_and_b32 v3, 0xffff0000, v209
    v_fmac_f32 v106, v2, v32
    v_fmac_f32 v107, v3, v32
    v_lshlrev_b32 v2, 16, v210
    v_and_b32 v3, 0xffff0000, v210
    v_fmac_f32 v108, v2, v32
    v_fmac_f32 v109, v3, v32
    v_lshlrev_b32 v2, 16, v211
    v_and_b32 v3, 0xffff0000, v211
    v_fmac_f32 v110, v2, v32
    v_fmac_f32 v111, v3, v32
    v_lshlrev_b32 v2, 16, v212
    v_and_b32 v3, 0xffff0000, v212
    v_fmac_f32 v112, v2, v32
    v_fmac_f32 v113, v3, v32
    v_lshlrev_b32 v2, 16, v213
    v_and_b32 v3, 0xffff0000, v213
    v_fmac_f32 v114, v2, v32
    v_fmac_f32 v115, v3, v32
    v_lshlrev_b32 v2, 16, v214
    v_and_b32 v3, 0xffff0000, v214
    v_fmac_f32 v116, v2, v32
    v_fmac_f32 v117, v3, v32
    v_lshlrev_b32 v2, 16, v216
    v_and_b32 v3, 0xffff0000, v216
    v_fmac_f32 v104, v2, v33
    v_fmac_f32 v105, v3, v33
    v_lshlrev_b32 v2, 16, v217
    v_and_b32 v3, 0xffff0000, v217
    v_fmac_f32 v106, v2, v33
    v_fmac_f32 v107, v3, v33
    v_lshlrev_b32 v2, 16, v218
    v_and_b32 v3, 0xffff0000, v218
    v_fmac_f32 v108, v2, v33
    v_fmac_f32 v109, v3, v33
    v_lshlrev_b32 v2, 16, v219
    v_and_b32 v3, 0xffff0000, v219
    v_fmac_f32 v110, v2, v33
    v_fmac_f32 v111, v3, v33
    v_lshlrev_b32 v2, 16, v220
    v_and_b32 v3, 0xffff0000, v220
    v_fmac_f32 v112, v2, v33
    v_fmac_f32 v113, v3, v33
    v_lshlrev_b32 v2, 16, v221
    v_and_b32 v3, 0xffff0000, v221
    v_fmac_f32 v114, v2, v33
    v_fmac_f32 v115, v3, v33
    v_lshlrev_b32 v2, 16, v222
    v_and_b32 v3, 0xffff0000, v222
    v_fmac_f32 v116, v2, v33
    v_fmac_f32 v117, v3, v33
    v_lshlrev_b32 v2, 16, v224
    v_and_b32 v3, 0xffff0000, v224
    v_fmac_f32 v104, v2, v34
    v_fmac_f32 v105, v3, v34
    v_lshlrev_b32 v2, 16, v225
    v_and_b32 v3, 0xffff0000, v225
    v_fmac_f32 v106, v2, v34
    v_fmac_f32 v107, v3, v34
    v_lshlrev_b32 v2, 16, v226
    v_and_b32 v3, 0xffff0000, v226
    v_fmac_f32 v108, v2, v34
    v_fmac_f32 v109, v3, v34
    v_lshlrev_b32 v2, 16, v227
    v_and_b32 v3, 0xffff0000, v227
    v_fmac_f32 v110, v2, v34
    v_fmac_f32 v111, v3, v34
    v_lshlrev_b32 v2, 16, v228
    v_and_b32 v3, 0xffff0000, v228
    v_fmac_f32 v112, v2, v34
    v_fmac_f32 v113, v3, v34
    v_lshlrev_b32 v2, 16, v229
    v_and_b32 v3, 0xffff0000, v229
    v_fmac_f32 v114, v2, v34
    v_fmac_f32 v115, v3, v34
    v_lshlrev_b32 v2, 16, v230
    v_and_b32 v3, 0xffff0000, v230
    v_fmac_f32 v116, v2, v34
    v_fmac_f32 v117, v3, v34
    v_lshlrev_b32 v2, 16, v232
    v_and_b32 v3, 0xffff0000, v232
    v_fmac_f32 v104, v2, v35
    v_fmac_f32 v105, v3, v35
    v_lshlrev_b32 v2, 16, v233
    v_and_b32 v3, 0xffff0000, v233
    v_fmac_f32 v106, v2, v35
    v_fmac_f32 v107, v3, v35
    v_lshlrev_b32 v2, 16, v234
    v_and_b32 v3, 0xffff0000, v234
    v_fmac_f32 v108, v2, v35
    v_fmac_f32 v109, v3, v35
    v_lshlrev_b32 v2, 16, v235
    v_and_b32 v3, 0xffff0000, v235
    v_fmac_f32 v110, v2, v35
    v_fmac_f32 v111, v3, v35
    v_lshlrev_b32 v2, 16, v236
    v_and_b32 v3, 0xffff0000, v236
    v_fmac_f32 v112, v2, v35
    v_fmac_f32 v113, v3, v35
    v_lshlrev_b32 v2, 16, v237
    v_and_b32 v3, 0xffff0000, v237
    v_fmac_f32 v114, v2, v35
    v_fmac_f32 v115, v3, v35
    v_lshlrev_b32 v2, 16, v238
    v_and_b32 v3, 0xffff0000, v238
    v_fmac_f32 v116, v2, v35
    v_fmac_f32 v117, v3, v35
    v_lshlrev_b32 v2, 16, v240
    v_and_b32 v3, 0xffff0000, v240
    v_fmac_f32 v104, v2, v36
    v_fmac_f32 v105, v3, v36
    v_lshlrev_b32 v2, 16, v241
    v_and_b32 v3, 0xffff0000, v241
    v_fmac_f32 v106, v2, v36
    v_fmac_f32 v107, v3, v36
    v_lshlrev_b32 v2, 16, v242
    v_and_b32 v3, 0xffff0000, v242
    v_fmac_f32 v108, v2, v36
    v_fmac_f32 v109, v3, v36
    v_lshlrev_b32 v2, 16, v243
    v_and_b32 v3, 0xffff0000, v243
    v_fmac_f32 v110, v2, v36
    v_fmac_f32 v111, v3, v36
    v_lshlrev_b32 v2, 16, v244
    v_and_b32 v3, 0xffff0000, v244
    v_fmac_f32 v112, v2, v36
    v_fmac_f32 v113, v3, v36
    v_lshlrev_b32 v2, 16, v245
    v_and_b32 v3, 0xffff0000, v245
    v_fmac_f32 v114, v2, v36
    v_fmac_f32 v115, v3, v36
    v_lshlrev_b32 v2, 16, v246
    v_and_b32 v3, 0xffff0000, v246
    v_fmac_f32 v116, v2, v36
    v_fmac_f32 v117, v3, v36
    v_lshlrev_b32 v2, 16, v248
    v_and_b32 v3, 0xffff0000, v248
    v_fmac_f32 v104, v2, v37
    v_fmac_f32 v105, v3, v37
    v_lshlrev_b32 v2, 16, v249
    v_and_b32 v3, 0xffff0000, v249
    v_fmac_f32 v106, v2, v37
    v_fmac_f32 v107, v3, v37
    v_lshlrev_b32 v2, 16, v250
    v_and_b32 v3, 0xffff0000, v250
    v_fmac_f32 v108, v2, v37
    v_fmac_f32 v109, v3, v37
    v_lshlrev_b32 v2, 16, v251
    v_and_b32 v3, 0xffff0000, v251
    v_fmac_f32 v110, v2, v37
    v_fmac_f32 v111, v3, v37
    v_lshlrev_b32 v2, 16, v252
    v_and_b32 v3, 0xffff0000, v252
    v_fmac_f32 v112, v2, v37
    v_fmac_f32 v113, v3, v37
    v_lshlrev_b32 v2, 16, v253
    v_and_b32 v3, 0xffff0000, v253
    v_fmac_f32 v114, v2, v37
    v_fmac_f32 v115, v3, v37
    v_lshlrev_b32 v2, 16, v254
    v_and_b32 v3, 0xffff0000, v254
    v_fmac_f32 v116, v2, v37
    v_fmac_f32 v117, v3, v37
    v_lshlrev_b32 v2, 16, v80
    v_and_b32 v3, 0xffff0000, v80
    v_fmac_f32 v104, v2, v38
    v_fmac_f32 v105, v3, v38
    v_lshlrev_b32 v2, 16, v81
    v_and_b32 v3, 0xffff0000, v81
    v_fmac_f32 v106, v2, v38
    v_fmac_f32 v107, v3, v38
    v_lshlrev_b32 v2, 16, v82
    v_and_b32 v3, 0xffff0000, v82
    v_fmac_f32 v108, v2, v38
    v_fmac_f32 v109, v3, v38
    v_lshlrev_b32 v2, 16, v83
    v_and_b32 v3, 0xffff0000, v83
    v_fmac_f32 v110, v2, v38
    v_fmac_f32 v111, v3, v38
    v_lshlrev_b32 v2, 16, v84
    v_and_b32 v3, 0xffff0000, v84
    v_fmac_f32 v112, v2, v38
    v_fmac_f32 v113, v3, v38
    v_lshlrev_b32 v2, 16, v85
    v_and_b32 v3, 0xffff0000, v85
    v_fmac_f32 v114, v2, v38
    v_fmac_f32 v115, v3, v38
    v_lshlrev_b32 v2, 16, v86
    v_and_b32 v3, 0xffff0000, v86
    v_fmac_f32 v116, v2, v38
    v_fmac_f32 v117, v3, v38
    v_lshlrev_b32 v2, 16, v88
    v_and_b32 v3, 0xffff0000, v88
    v_fmac_f32 v104, v2, v39
    v_fmac_f32 v105, v3, v39
    v_lshlrev_b32 v2, 16, v89
    v_and_b32 v3, 0xffff0000, v89
    v_fmac_f32 v106, v2, v39
    v_fmac_f32 v107, v3, v39
    v_lshlrev_b32 v2, 16, v90
    v_and_b32 v3, 0xffff0000, v90
    v_fmac_f32 v108, v2, v39
    v_fmac_f32 v109, v3, v39
    v_lshlrev_b32 v2, 16, v91
    v_and_b32 v3, 0xffff0000, v91
    v_fmac_f32 v110, v2, v39
    v_fmac_f32 v111, v3, v39
    v_lshlrev_b32 v2, 16, v92
    v_and_b32 v3, 0xffff0000, v92
    v_fmac_f32 v112, v2, v39
    v_fmac_f32 v113, v3, v39
    v_lshlrev_b32 v2, 16, v93
    v_and_b32 v3, 0xffff0000, v93
    v_fmac_f32 v114, v2, v39
    v_fmac_f32 v115, v3, v39
    v_lshlrev_b32 v2, 16, v94
    v_and_b32 v3, 0xffff0000, v94
    v_fmac_f32 v116, v2, v39
    v_fmac_f32 v117, v3, v39
    v_cvt_pk_bf16_f32 v24, v104, v105
    v_cvt_pk_bf16_f32 v25, v106, v107
    v_cvt_pk_bf16_f32 v26, v108, v109
    v_cvt_pk_bf16_f32 v27, v110, v111
    v_cvt_pk_bf16_f32 v28, v112, v113
    v_cvt_pk_bf16_f32 v29, v114, v115
    v_cvt_pk_bf16_f32 v30, v116, v117
    s_add_u32 s16, s20, 9437184
    s_addc_u32 s17, s21, 0
    s_mov_b32 s18, 3670016
    s_mov_b32 s19, 0x00020000
    s_movk_i32 s36, 1792
    v_mul_lo_u32 v2, v7, s36
    v_and_b32 v3, 1, v1
    v_mul_u32_u24 v3, 28, v3
    v_add_u32 v2, v2, v3
    s_mul_i32 s36, s4, 56
    s_add_u32 s36, s36, 896
    v_add_u32 v2, s36, v2
    buffer_store_dwordx4 v[24:27], v2, s[16:19], 0 offen
    buffer_store_dwordx3 v[28:30], v2, s[16:19], 0 offen offset:16
k2end_12:
    s_endpgm
.section .rodata,"a"
.p2align 6
.amdhsa_kernel k2_attn_kernel
  .amdhsa_next_free_vgpr 256
  .amdhsa_next_free_sgpr 102
  .amdhsa_accum_offset 256
  .amdhsa_group_segment_fixed_size 0
  .amdhsa_kernarg_size 96
  .amdhsa_user_sgpr_count 2
  .amdhsa_user_sgpr_kernarg_segment_ptr 1
  .amdhsa_system_sgpr_workgroup_id_x 1
.end_amdhsa_kernel
.text
.p2align 8
.globl k3_out_kernel
.type k3_out_kernel,@function
k3_out_kernel:
    s_cmp_ge_u32 s2, 224
    s_cbranch_scc1 k3end_20
    s_load_dwordx2 s[20:21], s[0:1], 88
    s_load_dwordx2 s[22:23], s[0:1], 32
    s_load_dwordx2 s[24:25], s[0:1], 56
    s_load_dwordx2 s[26:27], s[0:1], 72
    s_mov_b32 s3, 613566757
    s_mul_hi_u32 s4, s2, s3
    s_mul_i32 s5, s4, 7
    s_sub_u32 s5, s2, s5
    v_and_b32 v1, 63, v0
    v_bfe_u32 v4, v0, 3, 5
    v_lshlrev_b32 v2, 7, v4
    v_bfe_u32 v4, v0, 4, 1
    v_lshlrev_b32 v4, 2, v4
    v_and_b32 v9, 7, v0
    v_xor_b32 v4, v4, v9
    v_lshl_add_u32 v2, v4, 4, v2
    v_lshrrev_b32 v4, 5, v1
    v_lshlrev_b32 v3, 3, v4
    v_bfe_u32 v4, v1, 2, 2
    v_add_u32 v3, v3, v4
    v_lshlrev_b32 v3, 7, v3
    v_bfe_u32 v4, v1, 4, 1
    v_lshl_add_u32 v3, v4, 5, v3
    v_and_b32 v4, 3, v1
    v_lshl_add_u32 v3, v4, 3, v3
    v_bfe_u32 v4, v1, 3, 1
    v_lshl_add_u32 v3, v4, 6, v3
    v_xor_b32 v11, 64, v3
    v_lshrrev_b32 v4, 8, v0
    s_nop 0
    v_readfirstlane_b32 s34, v4
    v_bfe_u32 v4, v0, 7, 1
    v_lshlrev_b32 v7, 5, v4
    v_and_b32 v4, 31, v0
    v_add_u32 v7, v7, v4
    s_lshl_b32 s6, s4, 6
    v_add_u32 v7, s6, v7
    v_bfe_u32 v8, v0, 5, 1
    s_movk_i32 s7, 1792
    v_mul_lo_u32 v5, v7, s7
    v_lshl_add_u32 v5, v8, 4, v5
    s_mul_i32 s35, s34, 896
    v_add_u32 v5, s35, v5
    v_bfe_u32 v4, v0, 6, 1
    v_cmp_eq_u32 vcc, 1, v4
    s_mul_i32 s35, s34, 32768
    v_cndmask_b32 v3, v3, v11, vcc
    v_add_u32 v3, s35, v3
    v_add_u32 v2, s35, v2
    s_waitcnt lgkmcnt(0)
    s_add_u32 s8, s20, 9437184
    s_addc_u32 s9, s21, 0
    s_mov_b32 s10, 3670016
    s_mov_b32 s11, 0x00020000
    v_bfe_u32 v4, v0, 7, 1
    v_lshlrev_b32 v245, 5, v4
    v_and_b32 v4, 31, v0
    v_add_u32 v245, v245, v4
    v_bfe_u32 v4, v0, 3, 5
    v_and_b32 v9, 7, v4
    v_lshlrev_b32 v240, 7, v4
    v_and_b32 v4, 7, v0
    v_xor_b32 v4, v4, v9
    v_lshl_add_u32 v240, v4, 4, v240
    v_add_u32 v4, 0, v8
    v_and_b32 v9, 7, v245
    v_xor_b32 v4, v4, v9
    v_lshlrev_b32 v241, 7, v245
    v_lshl_add_u32 v241, v4, 4, v241
    v_add_u32 v4, 2, v8
    v_and_b32 v9, 7, v245
    v_xor_b32 v4, v4, v9
    v_lshlrev_b32 v242, 7, v245
    v_lshl_add_u32 v242, v4, 4, v242
    v_add_u32 v4, 4, v8
    v_and_b32 v9, 7, v245
    v_xor_b32 v4, v4, v9
    v_lshlrev_b32 v243, 7, v245
    v_lshl_add_u32 v243, v4, 4, v243
    v_add_u32 v4, 6, v8
    v_and_b32 v9, 7, v245
    v_xor_b32 v4, v4, v9
    v_lshlrev_b32 v244, 7, v245
    v_lshl_add_u32 v244, v4, 4, v244
    v_add_u32 v240, s35, v240
    v_add_u32 v241, s35, v241
    v_add_u32 v242, s35, v242
    v_add_u32 v243, s35, v243
    v_add_u32 v244, s35, v244
    v_bfe_u32 v4, v0, 3, 5
    v_add_u32 v4, s6, v4
    s_movk_i32 s7, 1792
    v_mul_lo_u32 v246, v4, s7
    v_and_b32 v4, 7, v0
    v_lshl_add_u32 v246, v4, 4, v246
    s_mul_i32 s36, s34, 896
    v_add_u32 v246, s36, v246
    s_lshl_b32 s6, s5, 7
    s_cmp_eq_u32 s34, 0
    s_cselect_b32 s12, s22, s24
    s_cselect_b32 s13, s23, s25
    s_add_u32 s12, s12, s6
    s_addc_u32 s13, s13, 0
    s_sub_u32 s14, 401408, s6
    s_mov_b32 s15, 0x00020000
    v_bfe_u32 v4, v0, 3, 5
    s_movk_i32 s7, 896
    v_mul_lo_u32 v6, v4, s7
    v_and_b32 v4, 7, v0
    v_lshl_add_u32 v6, v4, 4, v6
    s_mov_b32 s40, 0
    buffer_load_dwordx4 v[120:123], v246, s[8:11], s40 offen offset:0
    s_mov_b32 s40, 57344
    buffer_load_dwordx4 v[124:127], v246, s[8:11], s40 offen offset:0
    s_mov_b32 s41, 0
    buffer_load_dwordx4 v[64:67], v6, s[12:15], s41 offen
    s_mov_b32 s41, 28672
    buffer_load_dwordx4 v[68:71], v6, s[12:15], s41 offen
    s_mov_b32 s40, 0
    buffer_load_dwordx4 v[128:131], v246, s[8:11], s40 offen offset:128
    s_mov_b32 s40, 57344
    buffer_load_dwordx4 v[132:135], v246, s[8:11], s40 offen offset:128
    s_mov_b32 s41, 57344
    buffer_load_dwordx4 v[72:75], v6, s[12:15], s41 offen
    s_mov_b32 s41, 86016
    buffer_load_dwordx4 v[76:79], v6, s[12:15], s41 offen
    s_mov_b32 s40, 0
    buffer_load_dwordx4 v[136:139], v246, s[8:11], s40 offen offset:256
    s_mov_b32 s40, 57344
    buffer_load_dwordx4 v[140:143], v246, s[8:11], s40 offen offset:256
    s_mov_b32 s41, 114688
    buffer_load_dwordx4 v[80:83], v6, s[12:15], s41 offen
    s_mov_b32 s41, 143360
    buffer_load_dwordx4 v[84:87], v6, s[12:15], s41 offen
    s_mov_b32 s40, 0
    buffer_load_dwordx4 v[144:147], v246, s[8:11], s40 offen offset:384
    s_mov_b32 s40, 57344
    buffer_load_dwordx4 v[148:151], v246, s[8:11], s40 offen offset:384
    s_mov_b32 s41, 172032
    buffer_load_dwordx4 v[88:91], v6, s[12:15], s41 offen
    s_mov_b32 s41, 200704
    buffer_load_dwordx4 v[92:95], v6, s[12:15], s41 offen
    s_mov_b32 s40, 0
    buffer_load_dwordx4 v[152:155], v246, s[8:11], s40 offen offset:512
    s_mov_b32 s40, 57344
    buffer_load_dwordx4 v[156:159], v246, s[8:11], s40 offen offset:512
    s_mov_b32 s41, 229376
    buffer_load_dwordx4 v[96:99], v6, s[12:15], s41 offen
    s_mov_b32 s41, 258048
    buffer_load_dwordx4 v[100:103], v6, s[12:15], s41 offen
    s_mov_b32 s40, 0
    buffer_load_dwordx4 v[160:163], v246, s[8:11], s40 offen offset:640
    s_mov_b32 s40, 57344
    buffer_load_dwordx4 v[164:167], v246, s[8:11], s40 offen offset:640
    s_mov_b32 s41, 286720
    buffer_load_dwordx4 v[104:107], v6, s[12:15], s41 offen
    s_mov_b32 s41, 315392
    buffer_load_dwordx4 v[108:111], v6, s[12:15], s41 offen
    s_mov_b32 s40, 0
    buffer_load_dwordx4 v[168:171], v246, s[8:11], s40 offen offset:768
    s_mov_b32 s40, 57344
    buffer_load_dwordx4 v[172:175], v246, s[8:11], s40 offen offset:768
    s_mov_b32 s41, 344064
    buffer_load_dwordx4 v[112:115], v6, s[12:15], s41 offen
    s_mov_b32 s41, 372736
    buffer_load_dwordx4 v[116:119], v6, s[12:15], s41 offen
    v_mov_b32 v16, 0
    v_mov_b32 v17, 0
    v_mov_b32 v18, 0
    v_mov_b32 v19, 0
    v_mov_b32 v20, 0
    v_mov_b32 v21, 0
    v_mov_b32 v22, 0
    v_mov_b32 v23, 0
    v_mov_b32 v24, 0
    v_mov_b32 v25, 0
    v_mov_b32 v26, 0
    v_mov_b32 v27, 0
    v_mov_b32 v28, 0
    v_mov_b32 v29, 0
    v_mov_b32 v30, 0
    v_mov_b32 v31, 0
    s_waitcnt vmcnt(24)
    ds_write_b128 v2, v[64:67] offset:8192
    ds_write_b128 v2, v[68:71] offset:12288
    ds_write_b128 v240, v[120:123] offset:0
    ds_write_b128 v240, v[124:127] offset:4096
    s_waitcnt lgkmcnt(0)
    s_barrier
    ds_read_b64_tr_b16 v[48:49], v3 offset:8192
    ds_read_b64_tr_b16 v[50:51], v3 offset:8704
    ds_read_b128 v[232:235], v241 offset:0
    s_waitcnt vmcnt(20)
    ds_write_b128 v2, v[72:75] offset:24576
    ds_write_b128 v2, v[76:79] offset:28672
    ds_write_b128 v240, v[128:131] offset:16384
    ds_write_b128 v240, v[132:135] offset:20480
    ds_read_b64_tr_b16 v[52:53], v3 offset:10240
    ds_read_b64_tr_b16 v[54:55], v3 offset:10752
    ds_read_b128 v[236:239], v242 offset:0
    s_waitcnt lgkmcnt(3)
    v_mfma_f32_32x32x16_bf16 v[16:31], v[48:51], v[232:235], v[16:31]
    ds_read_b64_tr_b16 v[48:49], v3 offset:12288
    ds_read_b64_tr_b16 v[50:51], v3 offset:12800
    ds_read_b128 v[232:235], v243 offset:0
    s_waitcnt lgkmcnt(3)
    v_mfma_f32_32x32x16_bf16 v[16:31], v[52:55], v[236:239], v[16:31]
    ds_read_b64_tr_b16 v[52:53], v3 offset:14336
    ds_read_b64_tr_b16 v[54:55], v3 offset:14848
    ds_read_b128 v[236:239], v244 offset:0
    s_waitcnt lgkmcnt(3)
    v_mfma_f32_32x32x16_bf16 v[16:31], v[48:51], v[232:235], v[16:31]
    s_waitcnt lgkmcnt(0)
    v_mfma_f32_32x32x16_bf16 v[16:31], v[52:55], v[236:239], v[16:31]
    s_barrier
    ds_read_b64_tr_b16 v[48:49], v3 offset:24576
    ds_read_b64_tr_b16 v[50:51], v3 offset:25088
    ds_read_b128 v[232:235], v241 offset:16384
    s_waitcnt vmcnt(16)
    ds_write_b128 v2, v[80:83] offset:8192
    ds_write_b128 v2, v[84:87] offset:12288
    ds_write_b128 v240, v[136:139] offset:0
    ds_write_b128 v240, v[140:143] offset:4096
    ds_read_b64_tr_b16 v[52:53], v3 offset:26624
    ds_read_b64_tr_b16 v[54:55], v3 offset:27136
    ds_read_b128 v[236:239], v242 offset:16384
    s_waitcnt lgkmcnt(3)
    v_mfma_f32_32x32x16_bf16 v[16:31], v[48:51], v[232:235], v[16:31]
    ds_read_b64_tr_b16 v[48:49], v3 offset:28672
    ds_read_b64_tr_b16 v[50:51], v3 offset:29184
    ds_read_b128 v[232:235], v243 offset:16384
    s_waitcnt lgkmcnt(3)
    v_mfma_f32_32x32x16_bf16 v[16:31], v[52:55], v[236:239], v[16:31]
    ds_read_b64_tr_b16 v[52:53], v3 offset:30720
    ds_read_b64_tr_b16 v[54:55], v3 offset:31232
    ds_read_b128 v[236:239], v244 offset:16384
    s_waitcnt lgkmcnt(3)
    v_mfma_f32_32x32x16_bf16 v[16:31], v[48:51], v[232:235], v[16:31]
    s_waitcnt lgkmcnt(0)
    v_mfma_f32_32x32x16_bf16 v[16:31], v[52:55], v[236:239], v[16:31]
    s_barrier
    ds_read_b64_tr_b16 v[48:49], v3 offset:8192
    ds_read_b64_tr_b16 v[50:51], v3 offset:8704
    ds_read_b128 v[232:235], v241 offset:0
    s_waitcnt vmcnt(12)
    ds_write_b128 v2, v[88:91] offset:24576
    ds_write_b128 v2, v[92:95] offset:28672
    ds_write_b128 v240, v[144:147] offset:16384
    ds_write_b128 v240, v[148:151] offset:20480
    ds_read_b64_tr_b16 v[52:53], v3 offset:10240
    ds_read_b64_tr_b16 v[54:55], v3 offset:10752
    ds_read_b128 v[236:239], v242 offset:0
    s_waitcnt lgkmcnt(3)
    v_mfma_f32_32x32x16_bf16 v[16:31], v[48:51], v[232:235], v[16:31]
    ds_read_b64_tr_b16 v[48:49], v3 offset:12288
    ds_read_b64_tr_b16 v[50:51], v3 offset:12800
    ds_read_b128 v[232:235], v243 offset:0
    s_waitcnt lgkmcnt(3)
    v_mfma_f32_32x32x16_bf16 v[16:31], v[52:55], v[236:239], v[16:31]
    ds_read_b64_tr_b16 v[52:53], v3 offset:14336
    ds_read_b64_tr_b16 v[54:55], v3 offset:14848
    ds_read_b128 v[236:239], v244 offset:0
    s_waitcnt lgkmcnt(3)
    v_mfma_f32_32x32x16_bf16 v[16:31], v[48:51], v[232:235], v[16:31]
    s_waitcnt lgkmcnt(0)
    v_mfma_f32_32x32x16_bf16 v[16:31], v[52:55], v[236:239], v[16:31]
    s_barrier
    ds_read_b64_tr_b16 v[48:49], v3 offset:24576
    ds_read_b64_tr_b16 v[50:51], v3 offset:25088
    ds_read_b128 v[232:235], v241 offset:16384
    s_waitcnt vmcnt(8)
    ds_write_b128 v2, v[96:99] offset:8192
    ds_write_b128 v2, v[100:103] offset:12288
    ds_write_b128 v240, v[152:155] offset:0
    ds_write_b128 v240, v[156:159] offset:4096
    ds_read_b64_tr_b16 v[52:53], v3 offset:26624
    ds_read_b64_tr_b16 v[54:55], v3 offset:27136
    ds_read_b128 v[236:239], v242 offset:16384
    s_waitcnt lgkmcnt(3)
    v_mfma_f32_32x32x16_bf16 v[16:31], v[48:51], v[232:235], v[16:31]
    ds_read_b64_tr_b16 v[48:49], v3 offset:28672
    ds_read_b64_tr_b16 v[50:51], v3 offset:29184
    ds_read_b128 v[232:235], v243 offset:16384
    s_waitcnt lgkmcnt(3)
    v_mfma_f32_32x32x16_bf16 v[16:31], v[52:55], v[236:239], v[16:31]
    ds_read_b64_tr_b16 v[52:53], v3 offset:30720
    ds_read_b64_tr_b16 v[54:55], v3 offset:31232
    ds_read_b128 v[236:239], v244 offset:16384
    s_waitcnt lgkmcnt(3)
    v_mfma_f32_32x32x16_bf16 v[16:31], v[48:51], v[232:235], v[16:31]
    s_waitcnt lgkmcnt(0)
    v_mfma_f32_32x32x16_bf16 v[16:31], v[52:55], v[236:239], v[16:31]
    s_barrier
    ds_read_b64_tr_b16 v[48:49], v3 offset:8192
    ds_read_b64_tr_b16 v[50:51], v3 offset:8704
    ds_read_b128 v[232:235], v241 offset:0
    s_waitcnt vmcnt(4)
    ds_write_b128 v2, v[104:107] offset:24576
    ds_write_b128 v2, v[108:111] offset:28672
    ds_write_b128 v240, v[160:163] offset:16384
    ds_write_b128 v240, v[164:167] offset:20480
    ds_read_b64_tr_b16 v[52:53], v3 offset:10240
    ds_read_b64_tr_b16 v[54:55], v3 offset:10752
    ds_read_b128 v[236:239], v242 offset:0
    s_waitcnt lgkmcnt(3)
    v_mfma_f32_32x32x16_bf16 v[16:31], v[48:51], v[232:235], v[16:31]
    ds_read_b64_tr_b16 v[48:49], v3 offset:12288
    ds_read_b64_tr_b16 v[50:51], v3 offset:12800
    ds_read_b128 v[232:235], v243 offset:0
    s_waitcnt lgkmcnt(3)
    v_mfma_f32_32x32x16_bf16 v[16:31], v[52:55], v[236:239], v[16:31]
    ds_read_b64_tr_b16 v[52:53], v3 offset:14336
    ds_read_b64_tr_b16 v[54:55], v3 offset:14848
    ds_read_b128 v[236:239], v244 offset:0
    s_waitcnt lgkmcnt(3)
    v_mfma_f32_32x32x16_bf16 v[16:31], v[48:51], v[232:235], v[16:31]
    s_waitcnt lgkmcnt(0)
    v_mfma_f32_32x32x16_bf16 v[16:31], v[52:55], v[236:239], v[16:31]
    s_barrier
    ds_read_b64_tr_b16 v[48:49], v3 offset:24576
    ds_read_b64_tr_b16 v[50:51], v3 offset:25088
    ds_read_b128 v[232:235], v241 offset:16384
    s_waitcnt vmcnt(0)
    ds_write_b128 v2, v[112:115] offset:8192
    ds_write_b128 v2, v[116:119] offset:12288
    ds_write_b128 v240, v[168:171] offset:0
    ds_write_b128 v240, v[172:175] offset:4096
    ds_read_b64_tr_b16 v[52:53], v3 offset:26624
    ds_read_b64_tr_b16 v[54:55], v3 offset:27136
    ds_read_b128 v[236:239], v242 offset:16384
    s_waitcnt lgkmcnt(3)
    v_mfma_f32_32x32x16_bf16 v[16:31], v[48:51], v[232:235], v[16:31]
    ds_read_b64_tr_b16 v[48:49], v3 offset:28672
    ds_read_b64_tr_b16 v[50:51], v3 offset:29184
    ds_read_b128 v[232:235], v243 offset:16384
    s_waitcnt lgkmcnt(3)
    v_mfma_f32_32x32x16_bf16 v[16:31], v[52:55], v[236:239], v[16:31]
    ds_read_b64_tr_b16 v[52:53], v3 offset:30720
    ds_read_b64_tr_b16 v[54:55], v3 offset:31232
    ds_read_b128 v[236:239], v244 offset:16384
    s_waitcnt lgkmcnt(3)
    v_mfma_f32_32x32x16_bf16 v[16:31], v[48:51], v[232:235], v[16:31]
    s_waitcnt lgkmcnt(0)
    v_mfma_f32_32x32x16_bf16 v[16:31], v[52:55], v[236:239], v[16:31]
    s_barrier
    ds_read_b64_tr_b16 v[48:49], v3 offset:8192
    ds_read_b64_tr_b16 v[50:51], v3 offset:8704
    ds_read_b128 v[232:235], v241 offset:0
    ds_read_b64_tr_b16 v[52:53], v3 offset:10240
    ds_read_b64_tr_b16 v[54:55], v3 offset:10752
    ds_read_b128 v[236:239], v242 offset:0
    s_waitcnt lgkmcnt(3)
    v_mfma_f32_32x32x16_bf16 v[16:31], v[48:51], v[232:235], v[16:31]
    ds_read_b64_tr_b16 v[48:49], v3 offset:12288
    ds_read_b64_tr_b16 v[50:51], v3 offset:12800
    ds_read_b128 v[232:235], v243 offset:0
    s_waitcnt lgkmcnt(3)
    v_mfma_f32_32x32x16_bf16 v[16:31], v[52:55], v[236:239], v[16:31]
    ds_read_b64_tr_b16 v[52:53], v3 offset:14336
    ds_read_b64_tr_b16 v[54:55], v3 offset:14848
    ds_read_b128 v[236:239], v244 offset:0
    s_waitcnt lgkmcnt(3)
    v_mfma_f32_32x32x16_bf16 v[16:31], v[48:51], v[232:235], v[16:31]
    s_waitcnt lgkmcnt(0)
    v_mfma_f32_32x32x16_bf16 v[16:31], v[52:55], v[236:239], v[16:31]
    s_nop 15
    s_nop 3
    s_barrier
    v_bfe_u32 v4, v0, 6, 2
    v_lshlrev_b32 v4, 12, v4
    v_lshl_add_u32 v4, v1, 4, v4
    s_cmp_eq_u32 s34, 1
    s_cbranch_scc1 k3up_21
    s_barrier
    ds_read_b128 v[64:67], v4 offset:0
    ds_read_b128 v[68:71], v4 offset:1024
    ds_read_b128 v[72:75], v4 offset:2048
    ds_read_b128 v[76:79], v4 offset:3072
    s_waitcnt lgkmcnt(0)
    v_add_f32 v16, v16, v64
    v_add_f32 v17, v17, v65
    v_add_f32 v18, v18, v66
    v_add_f32 v19, v19, v67
    v_add_f32 v20, v20, v68
    v_add_f32 v21, v21, v69
    v_add_f32 v22, v22, v70
    v_add_f32 v23, v23, v71
    v_add_f32 v24, v24, v72
    v_add_f32 v25, v25, v73
    v_add_f32 v26, v26, v74
    v_add_f32 v27, v27, v75
    v_add_f32 v28, v28, v76
    v_add_f32 v29, v29, v77
    v_add_f32 v30, v30, v78
    v_add_f32 v31, v31, v79
    s_mov_b32 s16, s26
    s_mov_b32 s17, s27
    s_mov_b32 s18, 1835008
    s_mov_b32 s19, 0x00020000
    s_movk_i32 s7, 896
    v_mul_lo_u32 v10, v7, s7
    v_lshl_add_u32 v10, v8, 3, v10
    v_add_u32 v10, s6, v10
    v_bfe_u32 v4, v0, 6, 1
    v_lshl_add_u32 v10, v4, 6, v10
    v_cvt_pk_bf16_f32 v12, v16, v17
    v_cvt_pk_bf16_f32 v13, v18, v19
    buffer_store_dwordx2 v[12:13], v10, s[16:19], 0 offen offset:0
    s_nop 0
    v_cvt_pk_bf16_f32 v12, v20, v21
    v_cvt_pk_bf16_f32 v13, v22, v23
    buffer_store_dwordx2 v[12:13], v10, s[16:19], 0 offen offset:16
    s_nop 0
    v_cvt_pk_bf16_f32 v12, v24, v25
    v_cvt_pk_bf16_f32 v13, v26, v27
    buffer_store_dwordx2 v[12:13], v10, s[16:19], 0 offen offset:32
    s_nop 0
    v_cvt_pk_bf16_f32 v12, v28, v29
    v_cvt_pk_bf16_f32 v13, v30, v31
    buffer_store_dwordx2 v[12:13], v10, s[16:19], 0 offen offset:48
    s_nop 0
    s_branch k3end_20
k3up_21:
    ds_write_b128 v4, v[16:19] offset:0
    ds_write_b128 v4, v[20:23] offset:1024
    ds_write_b128 v4, v[24:27] offset:2048
    ds_write_b128 v4, v[28:31] offset:3072
    s_waitcnt lgkmcnt(0)
    s_barrier
k3end_20:
    s_endpgm
.section .rodata,"a"
.p2align 6
.amdhsa_kernel k3_out_kernel
  .amdhsa_next_free_vgpr 248
  .amdhsa_next_free_sgpr 102
  .amdhsa_accum_offset 248
  .amdhsa_group_segment_fixed_size 0
  .amdhsa_kernarg_size 96
  .amdhsa_user_sgpr_count 2
  .amdhsa_user_sgpr_kernarg_segment_ptr 1
  .amdhsa_system_sgpr_workgroup_id_x 1
.end_amdhsa_kernel
```
